```python
import torch

def _softmax(x, axis=-1):
    return torch.softmax(x, dim=axis)
def _gelu(x):
    return torch.nn.functional.gelu(x, approximate="tanh")
def _silu(x):
    return torch.nn.functional.silu(x)
def _sigmoid(x):
    return torch.sigmoid(x)
def _layernorm(x, axis=-1, eps=1e-5):
    m = x.mean(dim=axis, keepdim=True)
    v = x.var(dim=axis, keepdim=True, unbiased=False)
    return (x - m) / torch.sqrt(v + eps)
def _scatter_add(tgt, idx, src, axis=0):
    return tgt.clone().index_add_(axis, idx, src)
def _segment_sum(src, seg, n):
    out = torch.zeros((n,) + src.shape[1:], dtype=src.dtype)
    return out.index_add_(0, seg, src)
def _pad(x, pw):
    flat = tuple(v for pair in reversed(pw) for v in pair)
    return torch.nn.functional.pad(x, flat)

kernel_name = 'parallel_sum__sliding_block_cached__dense_activation_silu__decode'

def setup_inputs():

    _w = (lambda a: (lambda t: t.to(torch.bfloat16) if t.is_floating_point() else t)(torch.as_tensor(a)))
    def _A_setup():
        B, Sq, D = 4, 1, 576
        Hq, Hkv, Sk, Dh = 32, 16, 8192, 128
        assert Hq % Hkv == 0, (Hq, Hkv)
        return {
            "x": _w((lambda *s: torch.randn(*s, dtype=torch.bfloat16) * 0.05)(B, Sq, D)),
            "k_cache": _w((lambda *s: torch.randn(*s, dtype=torch.bfloat16) * 3.2)(B, Hkv, Sk, Dh)),
            "v_cache": _w((lambda *s: torch.randn(*s, dtype=torch.bfloat16) * 0.8)(B, Hkv, Sk, Dh)),
            "wq": _w((lambda *s: torch.randn(*s, dtype=torch.bfloat16) * 3.2)(D, Hq * Dh) * (D ** -0.5)),
            "wo": _w((lambda *s: torch.randn(*s, dtype=torch.bfloat16) * 0.8)(Hq * Dh, D) * ((Hq * Dh) ** -0.5)),
        }
    _A_in = _A_setup()

    def _B_setup():
        B, S, D, F = 4, 1, 576, 4608
        return {
            "x": _w((lambda *s: torch.randn(*s, dtype=torch.bfloat16) * 0.05)(B, S, D)),
            "w1": _w((lambda *s: torch.randn(*s, dtype=torch.bfloat16) * 3.2)(D, F) * (D ** -0.5)),
            "w2": _w((lambda *s: torch.randn(*s, dtype=torch.bfloat16) * 0.4)(F, D) * (F ** -0.5)),
        }
    _B_in = _B_setup()

    return {
        "A_x": _A_in["x"],
        "A_k_cache": _A_in["k_cache"],
        "A_v_cache": _A_in["v_cache"],
        "A_wq": _A_in["wq"],
        "A_wo": _A_in["wo"],
        "B_x": _B_in["x"],
        "B_w1": _B_in["w1"],
        "B_w2": _B_in["w2"],
    }

def reference(A_x, A_k_cache, A_v_cache, A_wq, A_wo, B_x, B_w1, B_w2):
    def _A_ref(x, k_cache, v_cache, wq, wo):
        B, Sq, D = x.shape
        Hq, Dh = 32, 128
        Hkv, Sk = k_cache.shape[1], k_cache.shape[2]
        W = min(4096, max(256, Sk // 4))
        rep = Hq // Hkv
        q = (lambda x, *d: x.permute(*d))((x @ wq).reshape(B, Sq, Hq, Dh), 0, 2, 1, 3)
        k = (lambda x, n, axis: torch.repeat_interleave(x, n, dim=axis))(k_cache[:, :, Sk - W:, :], rep, axis=1)
        v = (lambda x, n, axis: torch.repeat_interleave(x, n, dim=axis))(v_cache[:, :, Sk - W:, :], rep, axis=1)
        scores = torch.einsum("bhqd,bhkd->bhqk", q, k) * (Dh ** -0.5)
        p = _softmax(scores, axis=-1)
        o = torch.einsum("bhqk,bhkd->bhqd", p, v)
        return (lambda x, *d: x.permute(*d))(o, 0, 2, 1, 3).reshape(B, Sq, Hq * Dh) @ wo

    def _B_ref(x, w1, w2):
        h = torch.einsum("bsd,df->bsf", x, w1)
        h = _silu(h)
        out = torch.einsum("bsf,fd->bsd", h, w2)
        return out

    x = A_x
    xn = _layernorm(x, axis=-1)
    return x + _A_ref(xn, A_k_cache, A_v_cache, A_wq, A_wo) + _B_ref(xn, B_w1, B_w2)
```

```asm
; @launch grid=(256,1,1) block=(256,1,1) lds=158720
.amdgcn_target "amdgcn-amd-amdhsa--gfx950"
.text
.globl parallel_sum__sliding_block_cached__dense_activation_silu__decode_kernel
.p2align 8
.type parallel_sum__sliding_block_cached__dense_activation_silu__decode_kernel,@function
parallel_sum__sliding_block_cached__dense_activation_silu__decode_kernel:
    s_load_dwordx16 s[4:19], s[0:1], 0
    s_cmpk_ge_u32 s2, 256
    s_cbranch_scc1 L_end
    v_readfirstlane_b32 s88, v0
    s_and_b32 s72, s2, 7
    s_bfe_u32 s73, s2, 0x30003
    s_lshl3_add_u32 s64, s72, s73
    s_lshr_b32 s65, s2, 6
    s_getpc_b64 s[26:27]
L_pc:
    v_lshlrev_b32 v2, 6, v0
    v_min_u32 v2, L_end-L_pc, v2
    v_mov_b32 v3, s27
    v_add_co_u32 v2, vcc, s26, v2
    v_and_b32 v4, 63, v0
    s_lshr_b32 s3, s88, 6
    v_addc_co_u32 v3, vcc, 0, v3, vcc
    global_load_dword v1, v[2:3], off
    v_lshrrev_b32 v5, 3, v0
    v_and_b32 v6, 7, v0
    v_lshlrev_b32 v6, 4, v6
    v_lshl_or_b32 v10, v5, 13, v6
    s_lshl4_add_u32 m0, s88, 110592
    s_mul_i32 s73, s65, 1179648
    s_lshl_b32 s74, s64, 7
    s_add_u32 s73, s73, s74
    s_mov_b32 s42, 1171584
    s_mov_b32 s43, 0x20000
    s_lshl_b32 s87, s43, 1
    s_waitcnt lgkmcnt(0)
    s_add_u32 s40, s10, s73
    s_addc_u32 s41, s11, 0
    buffer_load_dwordx4 v10, s[40:43], 0 offen nt lds
    s_addk_i32 m0, 0x1000
    v_add_u32 v10, s87, v10
    buffer_load_dwordx4 v10, s[40:43], 0 offen nt lds
    s_addk_i32 m0, 0x1000
    v_add_u32 v10, s87, v10
    buffer_load_dwordx4 v10, s[40:43], 0 offen nt lds
    s_addk_i32 m0, 0x1000
    v_add_u32 v10, s87, v10
    buffer_load_dwordx4 v10, s[40:43], 0 offen nt lds
    s_addk_i32 m0, 0x1000
    v_add_u32 v10, s87, v10
    buffer_load_dwordx4 v10, s[40:43], 0 offen nt lds
    s_load_dwordx2 s[20:21], s[0:1], 64
    s_load_dwordx2 s[24:25], s[0:1], 80
    s_mul_i32 s72, s88, 18
    s_lshl_b32 s88, s88, 4
    v_lshlrev_b32 v9, 5, v4
    s_add_u32 s28, s4, s72
    s_addc_u32 s29, s5, 0
    s_mov_b32 s30, 1152
    s_mov_b32 s31, 0x20000
    buffer_load_dwordx4 v[12:15], v9, s[28:31], 0 offen
    buffer_load_dwordx4 v[16:19], v9, s[28:31], 0 offen offset:16
    s_mul_i32 s73, s65, 1327104
    s_mul_i32 s74, s64, 144
    s_add_u32 s73, s73, s74
    s_add_u32 s44, s16, s73
    s_addc_u32 s45, s17, 0
    s_mov_b32 s46, 1318032
    s_mov_b32 s47, 0x20000
    s_and_b32 s66, s64, 3
    s_lshr_b32 s67, s64, 2
    s_lshl4_add_u32 s72, s66, s67
    s_lshl_b32 s72, s72, 21
    s_lshl_b32 s73, s65, 14
    s_add_u32 s72, s72, s73
    s_add_u32 s72, s72, 1572864
    s_add_u32 s32, s6, s72
    s_addc_u32 s33, s7, 0
    s_mov_b32 s34, 475136
    s_mov_b32 s35, 0x20000
    s_add_u32 s36, s8, s72
    s_addc_u32 s37, s9, 0
    s_mov_b32 s38, 475136
    s_mov_b32 s39, 0x20000
    s_lshl2_add_u32 s68, s64, s65
    s_mov_b32 s69, 0
    s_bitcmp1_b32 s68, 5
    s_cselect_b32 s73, 1, 0
    s_add_u32 s69, s69, s73
    s_bitcmp1_b32 s68, 2
    s_cselect_b32 s73, 3, 0
    s_add_u32 s69, s69, s73
    s_bitcmp1_b32 s68, 1
    s_cselect_b32 s73, 2, 0
    s_add_u32 s69, s69, s73
    s_lshl_b32 s69, s69, 12
    s_and_b32 s69, s69, 0x1f000
    s_and_b32 s73, s69, 0x1c000
    s_mul_i32 s73, s73, 3
    s_add_u32 s69, s69, s73
    v_lshrrev_b32 v2, 4, v4
    v_and_b32 v3, 15, v4
    v_lshlrev_b32 v9, 4, v0
    v_lshlrev_b32 v5, 6, v2
    v_xor_b32 v22, v9, v5
    v_xor_b32 v23, 16, v22
    v_xor_b32 v24, 32, v22
    v_xor_b32 v25, 48, v22
    s_add_u32 m0, s88, 0
    s_mov_b32 s70, s69
    s_waitcnt vmcnt(8)
    buffer_load_dwordx4 v22, s[32:35], s70 offen nt lds
    v_lshlrev_b32 v11, 4, v0
    v_mul_u32_u24 v20, 7282, v0
    s_movk_i32 s87, 9072
    v_lshrrev_b32 v21, 16, v20
    s_add_u32 m0, s88, 134144
    v_mad_u32_u24 v21, v21, s87, v11
    s_waitcnt vmcnt(7)
    buffer_load_dwordx4 v21, s[44:47], 0 offen nt lds
    s_waitcnt lgkmcnt(0)
    s_load_dword s71, s[24:25], 0
    s_mov_b32 s56, s24
    s_mov_b32 s57, s25
    s_mov_b32 s58, 1073152
    s_mov_b32 s59, 0x20000
    s_mov_b32 s22, 0
    s_mov_b32 s23, 0
    s_add_u32 m0, s88, 4096
    s_add_u32 s70, s70, 0xd000
    s_and_b32 s70, s70, 0x73000
    s_waitcnt vmcnt(7)
    buffer_load_dwordx4 v23, s[32:35], s70 offen nt lds
    v_add_u32 v11, 0x1000, v11
    v_add_u32 v20, 1864192, v20
    s_movk_i32 s87, 9072
    v_lshrrev_b32 v21, 16, v20
    s_add_u32 m0, s88, 138240
    v_mad_u32_u24 v21, v21, s87, v11
    s_waitcnt vmcnt(7)
    buffer_load_dwordx4 v21, s[44:47], 0 offen nt lds
    s_add_u32 m0, s88, 8192
    s_add_u32 s70, s70, 0xd000
    s_and_b32 s70, s70, 0x73000
    s_waitcnt vmcnt(7)
    buffer_load_dwordx4 v24, s[32:35], s70 offen nt lds
    v_add_u32 v11, 0x1000, v11
    v_add_u32 v20, 1864192, v20
    s_movk_i32 s87, 9072
    v_lshrrev_b32 v21, 16, v20
    s_add_u32 m0, s88, 142336
    v_mad_u32_u24 v21, v21, s87, v11
    s_waitcnt vmcnt(7)
    buffer_load_dwordx4 v21, s[44:47], 0 offen nt lds
    s_waitcnt vmcnt(6)
    v_and_b32 v27, 0xffff0000, v12
    v_lshlrev_b32 v26, 16, v12
    v_and_b32 v29, 0xffff0000, v13
    v_lshlrev_b32 v28, 16, v13
    v_and_b32 v31, 0xffff0000, v14
    v_lshlrev_b32 v30, 16, v14
    v_and_b32 v33, 0xffff0000, v15
    v_lshlrev_b32 v32, 16, v15
    v_and_b32 v35, 0xffff0000, v16
    v_lshlrev_b32 v34, 16, v16
    v_and_b32 v37, 0xffff0000, v17
    v_lshlrev_b32 v36, 16, v17
    v_and_b32 v39, 0xffff0000, v18
    v_lshlrev_b32 v38, 16, v18
    v_and_b32 v41, 0xffff0000, v19
    v_lshlrev_b32 v40, 16, v19
    v_pk_add_f32 v[58:59], v[26:27], v[28:29]
    v_pk_add_f32 v[58:59], v[58:59], v[30:31]
    v_pk_add_f32 v[58:59], v[58:59], v[32:33]
    v_pk_add_f32 v[58:59], v[58:59], v[34:35]
    v_pk_add_f32 v[58:59], v[58:59], v[36:37]
    v_pk_add_f32 v[58:59], v[58:59], v[38:39]
    v_pk_add_f32 v[58:59], v[58:59], v[40:41]
    v_add_f32 v60, v58, v59
    s_nop 1
    v_add_f32_dpp v60, v60, v60 row_ror:8 row_mask:0xf bank_mask:0xf
    s_nop 1
    v_add_f32_dpp v60, v60, v60 row_ror:4 row_mask:0xf bank_mask:0xf
    s_nop 1
    v_add_f32_dpp v60, v60, v60 row_ror:2 row_mask:0xf bank_mask:0xf
    s_nop 1
    v_add_f32_dpp v60, v60, v60 row_ror:1 row_mask:0xf bank_mask:0xf
    v_mov_b32 v5, v60
    s_nop 1
    v_permlane16_swap_b32 v60, v5
    v_add_f32 v60, v60, v5
    v_mov_b32 v5, v60
    s_nop 1
    v_permlane32_swap_b32 v60, v5
    v_add_f32 v60, v60, v5
    v_mul_f32 v60, 0x3ae38e39, v60
    v_pk_add_f32 v[42:43], v[26:27], v[60:61] op_sel_hi:[1,0] neg_lo:[0,1] neg_hi:[0,1]
    v_pk_add_f32 v[44:45], v[28:29], v[60:61] op_sel_hi:[1,0] neg_lo:[0,1] neg_hi:[0,1]
    v_pk_add_f32 v[46:47], v[30:31], v[60:61] op_sel_hi:[1,0] neg_lo:[0,1] neg_hi:[0,1]
    v_pk_add_f32 v[48:49], v[32:33], v[60:61] op_sel_hi:[1,0] neg_lo:[0,1] neg_hi:[0,1]
    v_pk_add_f32 v[50:51], v[34:35], v[60:61] op_sel_hi:[1,0] neg_lo:[0,1] neg_hi:[0,1]
    v_pk_add_f32 v[52:53], v[36:37], v[60:61] op_sel_hi:[1,0] neg_lo:[0,1] neg_hi:[0,1]
    v_pk_add_f32 v[54:55], v[38:39], v[60:61] op_sel_hi:[1,0] neg_lo:[0,1] neg_hi:[0,1]
    v_pk_add_f32 v[56:57], v[40:41], v[60:61] op_sel_hi:[1,0] neg_lo:[0,1] neg_hi:[0,1]
    v_pk_mul_f32 v[58:59], v[42:43], v[42:43]
    v_pk_fma_f32 v[58:59], v[44:45], v[44:45], v[58:59]
    v_pk_fma_f32 v[58:59], v[46:47], v[46:47], v[58:59]
    v_pk_fma_f32 v[58:59], v[48:49], v[48:49], v[58:59]
    v_pk_fma_f32 v[58:59], v[50:51], v[50:51], v[58:59]
    v_pk_fma_f32 v[58:59], v[52:53], v[52:53], v[58:59]
    s_add_u32 m0, s88, 12288
    s_add_u32 s70, s70, 0xd000
    s_and_b32 s70, s70, 0x73000
    s_waitcnt vmcnt(8)
    buffer_load_dwordx4 v25, s[32:35], s70 offen nt lds
    v_add_u32 v11, 0x1000, v11
    v_add_u32 v20, 1864192, v20
    s_movk_i32 s87, 9072
    v_lshrrev_b32 v21, 16, v20
    s_add_u32 m0, s88, 146432
    v_mad_u32_u24 v21, v21, s87, v11
    s_waitcnt vmcnt(6)
    buffer_load_dwordx4 v21, s[44:47], 0 offen nt lds
    v_pk_fma_f32 v[58:59], v[54:55], v[54:55], v[58:59]
    v_pk_fma_f32 v[58:59], v[56:57], v[56:57], v[58:59]
    v_cmp_gt_u32 vcc, 36, v4
    v_add_f32 v6, v58, v59
    s_nop 0
    v_cndmask_b32 v6, 0, v6, vcc
    s_nop 1
    v_add_f32_dpp v6, v6, v6 row_ror:8 row_mask:0xf bank_mask:0xf
    s_nop 1
    v_add_f32_dpp v6, v6, v6 row_ror:4 row_mask:0xf bank_mask:0xf
    s_nop 1
    v_add_f32_dpp v6, v6, v6 row_ror:2 row_mask:0xf bank_mask:0xf
    s_nop 1
    v_add_f32_dpp v6, v6, v6 row_ror:1 row_mask:0xf bank_mask:0xf
    v_mov_b32 v5, v6
    s_nop 1
    v_permlane16_swap_b32 v6, v5
    v_add_f32 v6, v6, v5
    v_mov_b32 v5, v6
    s_nop 1
    v_permlane32_swap_b32 v6, v5
    v_add_f32 v6, v6, v5
    v_mul_f32 v6, 0x3ae38e39, v6
    v_cvt_pk_bf16_f32 v5, v60, v6
    v_lshlrev_b32 v60, 16, v5
    v_and_b32 v6, 0xffff0000, v5
    v_add_f32 v6, 0x3727c5ac, v6
    v_cvt_pk_bf16_f32 v6, v6, v6
    v_lshlrev_b32 v6, 16, v6
    v_sqrt_f32 v6, v6
    s_nop 0
    v_cvt_pk_bf16_f32 v6, v6, v6
    v_lshlrev_b32 v6, 16, v6
    v_rcp_f32 v58, v6
    v_pk_add_f32 v[42:43], v[26:27], v[60:61] op_sel_hi:[1,0] neg_lo:[0,1] neg_hi:[0,1]
    v_pk_add_f32 v[44:45], v[28:29], v[60:61] op_sel_hi:[1,0] neg_lo:[0,1] neg_hi:[0,1]
    v_pk_add_f32 v[46:47], v[30:31], v[60:61] op_sel_hi:[1,0] neg_lo:[0,1] neg_hi:[0,1]
    v_pk_add_f32 v[48:49], v[32:33], v[60:61] op_sel_hi:[1,0] neg_lo:[0,1] neg_hi:[0,1]
    v_pk_add_f32 v[50:51], v[34:35], v[60:61] op_sel_hi:[1,0] neg_lo:[0,1] neg_hi:[0,1]
    v_pk_add_f32 v[52:53], v[36:37], v[60:61] op_sel_hi:[1,0] neg_lo:[0,1] neg_hi:[0,1]
    v_pk_add_f32 v[54:55], v[38:39], v[60:61] op_sel_hi:[1,0] neg_lo:[0,1] neg_hi:[0,1]
    v_pk_add_f32 v[56:57], v[40:41], v[60:61] op_sel_hi:[1,0] neg_lo:[0,1] neg_hi:[0,1]
    v_cvt_pk_bf16_f32 v12, v42, v43
    v_cvt_pk_bf16_f32 v13, v44, v45
    v_cvt_pk_bf16_f32 v14, v46, v47
    v_cvt_pk_bf16_f32 v15, v48, v49
    v_cvt_pk_bf16_f32 v16, v50, v51
    v_cvt_pk_bf16_f32 v17, v52, v53
    v_cvt_pk_bf16_f32 v18, v54, v55
    v_cvt_pk_bf16_f32 v19, v56, v57
    v_and_b32 v27, 0xffff0000, v12
    v_lshlrev_b32 v26, 16, v12
    v_and_b32 v29, 0xffff0000, v13
    v_lshlrev_b32 v28, 16, v13
    v_and_b32 v31, 0xffff0000, v14
    v_lshlrev_b32 v30, 16, v14
    v_and_b32 v33, 0xffff0000, v15
    v_lshlrev_b32 v32, 16, v15
    v_and_b32 v35, 0xffff0000, v16
    v_lshlrev_b32 v34, 16, v16
    v_and_b32 v37, 0xffff0000, v17
    v_lshlrev_b32 v36, 16, v17
    v_and_b32 v39, 0xffff0000, v18
    v_lshlrev_b32 v38, 16, v18
    s_add_u32 m0, s88, 16384
    s_add_u32 s70, s70, 0xd000
    s_and_b32 s70, s70, 0x73000
    s_waitcnt vmcnt(6)
    buffer_load_dwordx4 v22, s[32:35], s70 offen nt lds
    v_add_u32 v11, 0x1000, v11
    v_add_u32 v20, 1864192, v20
    s_movk_i32 s87, 9072
    v_lshrrev_b32 v21, 16, v20
    s_add_u32 m0, s88, 150528
    v_mad_u32_u24 v21, v21, s87, v11
    s_waitcnt vmcnt(6)
    buffer_load_dwordx4 v21, s[44:47], 0 offen nt lds
    v_and_b32 v41, 0xffff0000, v19
    v_lshlrev_b32 v40, 16, v19
    v_pk_mul_f32 v[26:27], v[26:27], v[58:59] op_sel_hi:[1,0]
    v_pk_mul_f32 v[28:29], v[28:29], v[58:59] op_sel_hi:[1,0]
    v_pk_mul_f32 v[30:31], v[30:31], v[58:59] op_sel_hi:[1,0]
    v_pk_mul_f32 v[32:33], v[32:33], v[58:59] op_sel_hi:[1,0]
    v_pk_mul_f32 v[34:35], v[34:35], v[58:59] op_sel_hi:[1,0]
    v_pk_mul_f32 v[36:37], v[36:37], v[58:59] op_sel_hi:[1,0]
    v_pk_mul_f32 v[38:39], v[38:39], v[58:59] op_sel_hi:[1,0]
    v_pk_mul_f32 v[40:41], v[40:41], v[58:59] op_sel_hi:[1,0]
    v_cvt_pk_bf16_f32 v12, v26, v27
    v_cvt_pk_bf16_f32 v13, v28, v29
    v_cvt_pk_bf16_f32 v14, v30, v31
    v_cvt_pk_bf16_f32 v15, v32, v33
    v_cvt_pk_bf16_f32 v16, v34, v35
    v_cvt_pk_bf16_f32 v17, v36, v37
    v_cvt_pk_bf16_f32 v18, v38, v39
    v_cvt_pk_bf16_f32 v19, v40, v41
    s_mul_i32 s72, s65, 9
    s_sub_u32 s73, s3, s65
    s_mul_i32 s73, s73, 288
    s_add_u32 s73, s73, 131072
    v_lshl_add_u32 v5, v4, 5, s73
    s_lshl_b64 exec, 0x1ff, s72
    ds_write_b128 v5, v[12:15]
    ds_write_b128 v5, v[16:19] offset:16
    s_mov_b64 exec, -1
    s_waitcnt lgkmcnt(0)
    s_add_u32 s71, s71, 1
    s_mul_i32 s72, s71, 0x9E3779B1
    s_getreg_b32 s73, hwreg(HW_REG_XCC_ID, 0, 4)
    s_lshl_b32 s73, s73, 28
    s_add_u32 s74, s72, 0x4a3c5e12
    s_xor_b32 s72, s72, s73
    v_mov_b32 v10, s72
    v_mov_b32 v12, s74
    s_lshl_b32 s75, s71, 8
    s_and_b32 s75, s75, 0x7fff00
    s_or_b32 s75, s75, 0x4b000000
    v_mov_b32 v16, 0
    v_mov_b32 v17, 0
    v_mov_b32 v18, 0
    v_mov_b32 v19, s75
    s_mul_i32 s72, s65, 48
    s_add_u32 s72, s72, s64
    s_lshl_b32 s72, s72, 7
    s_add_u32 s72, s72, 1048576
    s_cmp_lt_u32 s64, 48
    s_cselect_b32 s73, 4, 0
    v_lshl_add_u32 v5, v0, 4, s72
    v_cmp_gt_u32 vcc, s73, v0
    v_mov_b32 v6, 0x40000000
    s_nop 0
    v_cndmask_b32 v5, v6, v5, vcc
    buffer_store_dwordx4 v[16:19], v5, s[56:59], 0 offen sc1
    s_mov_b32 s76, 0x7060500
    s_mov_b32 s77, 0x7060501
    s_mov_b32 s78, 0x7060502
    s_mov_b32 s79, 0x7060503
    s_mov_b32 s80, 0x0c0c0400
    s_mov_b32 s81, 0x04000c0c
    s_mov_b32 s82, 0xf000f0
    s_mov_b32 s83, 0xf000f0
    s_mov_b32 s84, 0xf000f00
    s_mov_b32 s85, 0xf000f00
    s_mov_b32 s86, 2097152
    v_and_b32 v13, 3, v4
    s_add_u32 m0, s88, 20480
    s_add_u32 s70, s70, 0xd000
    s_and_b32 s70, s70, 0x73000
    s_waitcnt vmcnt(7)
    buffer_load_dwordx4 v23, s[32:35], s70 offen nt lds
    v_add_u32 v11, 0x1000, v11
    v_add_u32 v20, 1864192, v20
    s_movk_i32 s87, 9072
    v_lshrrev_b32 v21, 16, v20
    s_add_u32 m0, s88, 154624
    v_mad_u32_u24 v21, v21, s87, v11
    s_waitcnt vmcnt(7)
    buffer_load_dwordx4 v21, s[44:47], 0 offen nt lds
    v_lshrrev_b32 v14, 2, v4
    v_mul_u32_u24 v11, 288, v13
    v_lshl_add_u32 v11, v2, 3, v11
    v_add_u32 v11, 131072, v11
    s_lshl_b32 s72, s3, 5
    v_lshlrev_b32 v7, 3, v13
    v_lshl_add_u32 v15, v14, 7, v7
    s_add_u32 s73, s72, 110592
    v_add_u32 v15, s73, v15
    v_mul_u32_u24 v17, 144, v14
    v_add_u32 v17, v17, v7
    v_add_u32 v17, 134144, v17
    v_add_u32 v16, s72, v17
    s_lshl_b32 s72, s3, 6
    v_lshlrev_b32 v7, 4, v2
    v_lshl_add_u32 v18, v13, 8, v7
    v_add_u32 v18, s72, v18
    v_mul_u32_u24 v8, 288, v13
    v_add_u32 v8, v8, v7
    s_add_u32 s72, s72, 1024
    v_add_u32 v5, s72, v8
    v_cndmask_b32 v18, v18, v5, s[82:83]
    v_add_u32 v5, 1280, v8
    v_cndmask_b32 v18, v18, v5, s[84:85]
    s_lshl_b32 s72, 0x01000100, s3
    s_or_b32 vcc_lo, s72, 0x00ff00ff
    s_mov_b32 vcc_hi, 0x00ff00ff
    s_mul_i32 s72, s68, 2304
    s_add_u32 s72, s72, 4096
    v_add_u32 v18, s72, v18
    v_mov_b32 v5, 0x40000000
    v_cndmask_b32 v18, v5, v18, vcc
    s_add_u32 m0, s88, 24576
    s_add_u32 s70, s70, 0xd000
    s_and_b32 s70, s70, 0x73000
    s_waitcnt vmcnt(7)
    buffer_load_dwordx4 v24, s[32:35], s70 offen nt lds
    s_add_u32 m0, s88, 28672
    s_add_u32 s70, s70, 0xd000
    s_and_b32 s70, s70, 0x73000
    s_waitcnt vmcnt(7)
    buffer_load_dwordx4 v25, s[32:35], s70 offen nt lds
    s_add_u32 m0, s88, 32768
    s_add_u32 s70, s70, 0xd000
    s_and_b32 s70, s70, 0x73000
    s_waitcnt vmcnt(7)
    buffer_load_dwordx4 v22, s[32:35], s70 offen nt lds
    s_add_u32 m0, s88, 36864
    s_add_u32 s70, s70, 0xd000
    s_and_b32 s70, s70, 0x73000
    s_waitcnt vmcnt(7)
    buffer_load_dwordx4 v23, s[32:35], s70 offen nt lds
    s_add_u32 m0, s88, 40960
    s_add_u32 s70, s70, 0xd000
    s_and_b32 s70, s70, 0x73000
    s_waitcnt vmcnt(7)
    buffer_load_dwordx4 v24, s[32:35], s70 offen nt lds
    s_add_u32 m0, s88, 45056
    s_add_u32 s70, s70, 0xd000
    s_and_b32 s70, s70, 0x73000
    s_waitcnt vmcnt(6)
    buffer_load_dwordx4 v25, s[32:35], s70 offen nt lds
    s_waitcnt vmcnt(6)
    s_barrier
    s_add_u32 m0, s88, 49152
    s_add_u32 s70, s70, 0xd000
    s_and_b32 s70, s70, 0x73000
    s_waitcnt vmcnt(5)
    buffer_load_dwordx4 v22, s[32:35], s70 offen nt lds
    ds_read_b64 v[26:27], v11 offset:0
    ds_read_b64_tr_b16 v[28:29], v15 offset:0
    ds_read_b64_tr_b16 v[30:31], v16 offset:0
    ds_read_b64_tr_b16 v[32:33], v17 offset:128
    ds_read_b64 v[34:35], v11 offset:32
    ds_read_b64_tr_b16 v[36:37], v15 offset:2048
    ds_read_b64_tr_b16 v[38:39], v16 offset:2304
    ds_read_b64_tr_b16 v[40:41], v17 offset:2432
    ds_read_b64 v[42:43], v11 offset:64
    ds_read_b64_tr_b16 v[44:45], v15 offset:4096
    ds_read_b64_tr_b16 v[46:47], v16 offset:4608
    ds_read_b64_tr_b16 v[48:49], v17 offset:4736
    s_waitcnt lgkmcnt(0)
    ds_read_b64 v[50:51], v11 offset:96
    ds_read_b64_tr_b16 v[52:53], v15 offset:6144
    ds_read_b64_tr_b16 v[54:55], v16 offset:6912
    ds_read_b64_tr_b16 v[56:57], v17 offset:7040
    ds_read_b64 v[58:59], v11 offset:128
    ds_read_b64_tr_b16 v[60:61], v15 offset:8192
    ds_read_b64_tr_b16 v[62:63], v16 offset:9216
    ds_read_b64_tr_b16 v[64:65], v17 offset:9344
    ds_read_b64 v[66:67], v11 offset:160
    ds_read_b64_tr_b16 v[68:69], v15 offset:10240
    ds_read_b64_tr_b16 v[70:71], v16 offset:11520
    ds_read_b64_tr_b16 v[72:73], v17 offset:11648
    v_mfma_f32_16x16x16_bf16 v[76:79], v[28:29], v[26:27], 0
    v_mfma_f32_16x16x16_bf16 v[80:83], v[30:31], v[26:27], 0
    v_mfma_f32_16x16x16_bf16 v[84:87], v[32:33], v[26:27], 0
    s_add_u32 m0, s88, 53248
    s_add_u32 s70, s70, 0xd000
    s_and_b32 s70, s70, 0x73000
    s_waitcnt vmcnt(6)
    buffer_load_dwordx4 v23, s[32:35], s70 offen nt lds
    v_mfma_f32_16x16x16_bf16 v[76:79], v[36:37], v[34:35], v[76:79]
    v_mfma_f32_16x16x16_bf16 v[80:83], v[38:39], v[34:35], v[80:83]
    v_mfma_f32_16x16x16_bf16 v[84:87], v[40:41], v[34:35], v[84:87]
    v_mfma_f32_16x16x16_bf16 v[76:79], v[44:45], v[42:43], v[76:79]
    v_mfma_f32_16x16x16_bf16 v[80:83], v[46:47], v[42:43], v[80:83]
    v_mfma_f32_16x16x16_bf16 v[84:87], v[48:49], v[42:43], v[84:87]
    s_waitcnt lgkmcnt(0)
    s_nop 7
    ds_read_b64 v[26:27], v11 offset:192
    ds_read_b64_tr_b16 v[28:29], v15 offset:12288
    ds_read_b64_tr_b16 v[30:31], v16 offset:13824
    ds_read_b64_tr_b16 v[32:33], v17 offset:13952
    ds_read_b64 v[34:35], v11 offset:224
    ds_read_b64_tr_b16 v[36:37], v15 offset:14336
    ds_read_b64_tr_b16 v[38:39], v16 offset:16128
    ds_read_b64_tr_b16 v[40:41], v17 offset:16256
    ds_read_b64 v[42:43], v11 offset:256
    ds_read_b64_tr_b16 v[44:45], v15 offset:16384
    ds_read_b64_tr_b16 v[46:47], v16 offset:18432
    ds_read_b64_tr_b16 v[48:49], v17 offset:18560
    v_mfma_f32_16x16x16_bf16 v[76:79], v[52:53], v[50:51], v[76:79]
    v_mfma_f32_16x16x16_bf16 v[80:83], v[54:55], v[50:51], v[80:83]
    v_mfma_f32_16x16x16_bf16 v[84:87], v[56:57], v[50:51], v[84:87]
    s_add_u32 m0, s88, 57344
    s_add_u32 s70, s70, 0xd000
    s_and_b32 s70, s70, 0x73000
    s_waitcnt vmcnt(6)
    buffer_load_dwordx4 v24, s[32:35], s70 offen nt lds
    v_mfma_f32_16x16x16_bf16 v[76:79], v[60:61], v[58:59], v[76:79]
    v_mfma_f32_16x16x16_bf16 v[80:83], v[62:63], v[58:59], v[80:83]
    v_mfma_f32_16x16x16_bf16 v[84:87], v[64:65], v[58:59], v[84:87]
    v_mfma_f32_16x16x16_bf16 v[76:79], v[68:69], v[66:67], v[76:79]
    v_mfma_f32_16x16x16_bf16 v[80:83], v[70:71], v[66:67], v[80:83]
    v_mfma_f32_16x16x16_bf16 v[84:87], v[72:73], v[66:67], v[84:87]
    s_waitcnt lgkmcnt(0)
    v_mfma_f32_16x16x16_bf16 v[76:79], v[28:29], v[26:27], v[76:79]
    v_mfma_f32_16x16x16_bf16 v[80:83], v[30:31], v[26:27], v[80:83]
    v_mfma_f32_16x16x16_bf16 v[84:87], v[32:33], v[26:27], v[84:87]
    v_mfma_f32_16x16x16_bf16 v[76:79], v[36:37], v[34:35], v[76:79]
    v_mfma_f32_16x16x16_bf16 v[80:83], v[38:39], v[34:35], v[80:83]
    v_mfma_f32_16x16x16_bf16 v[84:87], v[40:41], v[34:35], v[84:87]
    v_mfma_f32_16x16x16_bf16 v[76:79], v[44:45], v[42:43], v[76:79]
    v_mfma_f32_16x16x16_bf16 v[80:83], v[46:47], v[42:43], v[80:83]
    v_mfma_f32_16x16x16_bf16 v[84:87], v[48:49], v[42:43], v[84:87]
    s_add_u32 m0, s88, 61440
    s_add_u32 s70, s70, 0xd000
    s_and_b32 s70, s70, 0x73000
    s_waitcnt vmcnt(6)
    buffer_load_dwordx4 v25, s[32:35], s70 offen nt lds
    s_nop 1
    v_cndmask_b32 v88, v76, v80, s[82:83]
    v_cndmask_b32 v89, v77, v81, s[82:83]
    v_cndmask_b32 v90, v78, v82, s[82:83]
    v_cndmask_b32 v91, v79, v83, s[82:83]
    v_cndmask_b32 v88, v88, v84, s[84:85]
    v_cndmask_b32 v89, v89, v85, s[84:85]
    v_cndmask_b32 v90, v90, v86, s[84:85]
    v_cndmask_b32 v91, v91, v87, s[84:85]
    v_add_u32 v88, 0x80, v88
    v_add_u32 v89, 0x80, v89
    v_add_u32 v90, 0x80, v90
    v_add_u32 v91, 0x80, v91
    v_perm_b32 v88, v88, v10, s76
    v_perm_b32 v89, v89, v10, s77
    v_perm_b32 v90, v90, v10, s78
    v_perm_b32 v91, v91, v10, s79
    buffer_store_dwordx4 v[88:91], v18, s[56:59], 0 offen
    s_add_u32 m0, s88, 65536
    s_add_u32 s70, s70, 0xd000
    s_and_b32 s70, s70, 0x73000
    s_waitcnt vmcnt(6)
    buffer_load_dwordx4 v22, s[32:35], s70 offen nt lds
    s_barrier
    v_mul_u32_u24 v7, 2304, v2
    v_lshl_add_u32 v7, v3, 4, v7
    s_lshl2_add_u32 s72, s67, s3
    s_mul_i32 s72, s72, 9216
    s_lshl_b32 s73, s66, 8
    s_add_u32 s72, s72, s73
    s_add_u32 s72, s72, 4096
    v_add_u32 v11, s72, v7
    s_mul_i32 s72, s64, 9216
    s_mul_i32 s73, s3, 288
    s_add_u32 s72, s72, s73
    s_add_u32 s72, s72, 5120
    v_add_u32 v15, s72, v7
    v_cmp_gt_u32 vcc, 2, v3
    v_add_u32 v16, 256, v15
    v_mov_b32 v5, 0x40000000
    v_cndmask_b32 v16, v5, v16, vcc
    v_and_b32 v5, 1, v4
    v_lshlrev_b32 v5, 4, v5
    v_mov_b32 v6, 0xffff
    v_lshlrev_b32 v6, v5, v6
    v_bfe_u32 v5, v4, 1, 2
    v_cmp_eq_u32 vcc, 0, v5
    s_nop 1
    v_cndmask_b32 v18, 0, v6, vcc
    v_cmp_eq_u32 vcc, 1, v5
    s_nop 1
    v_cndmask_b32 v19, 0, v6, vcc
    v_cmp_eq_u32 vcc, 2, v5
    s_nop 1
    v_cndmask_b32 v20, 0, v6, vcc
    v_cmp_eq_u32 vcc, 3, v5
    s_nop 1
    v_cndmask_b32 v21, 0, v6, vcc
    v_lshl_add_u32 v5, v3, 2, v2
    v_lshlrev_b32 v5, 1, v5
    s_lshl_b32 s72, s3, 7
    s_add_u32 s72, s72, 132224
    v_add_u32 v17, s72, v5
    s_mul_i32 s72, s3, 160
    s_add_u32 s72, s72, 132736
    v_add_u32 v26, s72, v5
    s_add_u32 m0, s88, 69632
    s_add_u32 s70, s70, 0xd000
    s_and_b32 s70, s70, 0x73000
    s_waitcnt vmcnt(7)
    buffer_load_dwordx4 v23, s[32:35], s70 offen nt lds
    v_lshrrev_b32 v5, 3, v3
    v_lshlrev_b32 v5, 8, v5
    v_lshl_add_u32 v27, v2, 4, v5
    v_add_u32 v27, 132224, v27
    v_xor_b32 v5, v2, v3
    v_lshlrev_b32 v5, 4, v5
    v_lshl_add_u32 v5, v13, 12, v5
    v_lshrrev_b32 v6, 2, v3
    v_lshl_add_u32 v5, v6, 8, v5
    v_add_u32 v28, s88, v5
    v_xor_b32 v29, 64, v28
    v_xor_b32 v30, 128, v28
    v_xor_b32 v31, 192, v28
    v_lshrrev_b32 v5, 1, v2
    v_lshlrev_b32 v5, 9, v5
    v_lshl_add_u32 v5, v3, 5, v5
    v_and_b32 v6, 1, v2
    v_lshl_add_u32 v5, v6, 4, v5
    v_add_u32 v32, s88, v5
    s_lshl_b32 s73, s3, 8
    v_lshl_add_u32 v33, v3, 4, s73
    s_mul_i32 s72, s68, 2304
    s_add_u32 s72, s72, 4096
    v_add_u32 v34, s72, v33
    v_and_b32 v5, 12, v4
    v_add_u32 v5, v5, v2
    v_mul_u32_u24 v5, 2304, v5
    s_mul_i32 s72, s67, 36864
    s_add_u32 s72, s72, 4096
    s_add_u32 s73, s72, 2176
    v_add_u32 v36, s73, v5
    s_lshl2_add_u32 s73, s66, s3
    s_lshl_b32 s73, s73, 6
    s_add_u32 s72, s72, s73
    v_lshl_add_u32 v5, v13, 4, v5
    v_add_u32 v35, s72, v5
    s_lshr_b32 s72, s3, 1
    s_lshl_b32 s72, s72, 6
    s_and_b32 s73, s3, 1
    s_lshl3_add_u32 s72, s73, s72
    s_add_u32 s72, s72, 133504
    v_and_b32 v5, 12, v4
    v_lshlrev_b32 v5, 5, v5
    v_lshl_add_u32 v5, v13, 4, v5
    v_lshl_add_u32 v5, v2, 1, v5
    v_add_u32 v37, s72, v5
    v_and_b32 v6, 3, v14
    v_lshlrev_b32 v5, 7, v6
    v_lshl_add_u32 v5, v2, 4, v5
    v_add_u32 v38, 133504, v5
    v_mul_u32_u24 v5, 160, v6
    v_lshl_add_u32 v5, v2, 3, v5
    v_add_u32 v39, 132736, v5
    v_mul_u32_u24 v5, 288, v14
    v_lshl_add_u32 v5, v13, 3, v5
    s_mul_i32 s74, s3, 96
    s_add_u32 s72, s74, 110592
    v_add_u32 v40, s72, v5
    s_mul_i32 s72, s65, 3
    s_add_u32 s72, s72, s3
    s_lshl_b32 s72, s72, 11
    s_add_u32 s72, s72, 1048576
    v_lshlrev_b32 v5, 9, v2
    v_lshl_add_u32 v5, v3, 2, v5
    v_add_u32 v41, s72, v5
    s_mul_i32 s73, s65, 288
    s_mul_i32 s72, s64, 82944
    s_add_u32 s72, s72, s73
    s_add_u32 s48, s18, s72
    s_addc_u32 s49, s19, 0
    s_mov_b32 s50, 82080
    s_mov_b32 s51, 0x20000
    s_mul_i32 s72, s64, 73728
    s_add_u32 s72, s72, s73
    s_add_u32 s52, s12, s72
    s_addc_u32 s53, s13, 0
    s_mov_b32 s54, 72864
    s_mov_b32 s55, 0x20000
    s_add_u32 s72, s73, s74
    v_mul_u32_u24 v5, 1152, v6
    s_add_u32 m0, s88, 73728
    s_add_u32 s70, s70, 0xd000
    s_and_b32 s70, s70, 0x73000
    s_waitcnt vmcnt(7)
    buffer_load_dwordx4 v24, s[32:35], s70 offen nt lds
    v_lshl_add_u32 v5, v13, 5, v5
    v_lshl_add_u32 v5, v2, 3, v5
    v_add_u32 v42, s72, v5
    s_mov_b32 s82, 0x22222222
    s_mov_b32 s83, 0x22222222
    s_mov_b32 s84, 0x44444444
    s_mov_b32 s85, 0x44444444
    s_mov_b32 s96, 0x88888888
    s_mov_b32 s97, 0x88888888
    v_mov_b32 v5, 0x40000000
    v_cndmask_b32 v42, v42, v5, s[96:97]
    s_mov_b32 s28, s4
    s_mov_b32 s29, s5
    s_mov_b32 s30, 4608
    s_mov_b32 s31, 0x20000
    s_mov_b32 s60, s20
    s_mov_b32 s61, s21
    s_mov_b32 s62, 4608
    s_mov_b32 s63, 0x20000
    s_cmp_eq_u32 s64, 0
    s_cselect_b32 s30, s30, 0
    buffer_load_dwordx2 v[44:45], v42, s[28:31], 0 offen
    s_add_u32 m0, s88, 77824
    s_add_u32 s70, s70, 0xd000
    s_and_b32 s70, s70, 0x73000
    s_waitcnt vmcnt(7)
    buffer_load_dwordx4 v25, s[32:35], s70 offen nt lds
    s_add_u32 m0, s88, 81920
    s_add_u32 s70, s70, 0xd000
    s_and_b32 s70, s70, 0x73000
    s_waitcnt vmcnt(7)
    buffer_load_dwordx4 v22, s[32:35], s70 offen nt lds
    s_add_u32 m0, s88, 86016
    s_add_u32 s70, s70, 0xd000
    s_and_b32 s70, s70, 0x73000
    s_waitcnt vmcnt(7)
    buffer_load_dwordx4 v23, s[32:35], s70 offen nt lds
    s_add_u32 m0, s88, 90112
    s_add_u32 s70, s70, 0xd000
    s_and_b32 s70, s70, 0x73000
    s_waitcnt vmcnt(6)
    buffer_load_dwordx4 v24, s[32:35], s70 offen nt lds
    s_add_u32 m0, s88, 94208
    s_add_u32 s70, s70, 0xd000
    s_and_b32 s70, s70, 0x73000
    s_waitcnt vmcnt(6)
    buffer_load_dwordx4 v25, s[32:35], s70 offen nt lds
    s_add_u32 m0, s88, 98304
    s_add_u32 s70, s70, 0xd000
    s_and_b32 s70, s70, 0x73000
    s_waitcnt vmcnt(6)
    buffer_load_dwordx4 v22, s[32:35], s70 offen nt lds
    s_add_u32 m0, s88, 102400
    s_add_u32 s70, s70, 0xd000
    s_and_b32 s70, s70, 0x73000
    s_waitcnt vmcnt(5)
    buffer_load_dwordx4 v23, s[32:35], s70 offen nt lds
    buffer_load_dwordx4 v[48:51], v11, s[56:59], 0 offen sc1
    buffer_load_dwordx4 v[52:55], v15, s[56:59], 0 offen sc1
    buffer_load_dwordx4 v[56:59], v16, s[56:59], 0 offen sc1
    s_add_u32 m0, s88, 106496
    s_add_u32 s70, s70, 0xd000
    s_and_b32 s70, s70, 0x73000
    s_waitcnt vmcnt(8)
    buffer_load_dwordx4 v24, s[32:35], s70 offen nt lds
    s_add_u32 m0, s88, 110592
    s_add_u32 s70, s70, 0xd000
    s_and_b32 s70, s70, 0x73000
    s_waitcnt vmcnt(8)
    buffer_load_dwordx4 v25, s[32:35], s70 offen nt lds
    s_add_u32 m0, s88, 114688
    s_add_u32 s70, s70, 0xd000
    s_and_b32 s70, s70, 0x73000
    s_waitcnt vmcnt(8)
    buffer_load_dwordx4 v22, s[32:35], s70 offen nt lds
    s_add_u32 m0, s88, 118784
    s_add_u32 s70, s70, 0xd000
    s_and_b32 s70, s70, 0x73000
    s_waitcnt vmcnt(8)
    buffer_load_dwordx4 v23, s[32:35], s70 offen nt lds
    s_add_u32 m0, s88, 122880
    s_add_u32 s70, s70, 0xd000
    s_and_b32 s70, s70, 0x73000
    s_waitcnt vmcnt(8)
    buffer_load_dwordx4 v24, s[32:35], s70 offen nt lds
    s_add_u32 m0, s88, 126976
    s_add_u32 s70, s70, 0xd000
    s_and_b32 s70, s70, 0x73000
    s_waitcnt vmcnt(8)
    buffer_load_dwordx4 v25, s[32:35], s70 offen nt lds
    s_waitcnt vmcnt(6)
L_chk1:
    v_perm_b32 v5, v49, v48, s80
    v_perm_b32 v6, v51, v50, s81
    v_or_b32 v5, v5, v6
    v_cmp_ne_u32 s[90:91], v5, v10
    v_perm_b32 v5, v53, v52, s80
    v_perm_b32 v6, v55, v54, s81
    v_or_b32 v5, v5, v6
    v_cmp_ne_u32 s[92:93], v5, v10
    v_perm_b32 v5, v57, v56, s80
    v_perm_b32 v6, v59, v58, s81
    v_or_b32 v5, v5, v6
    v_cmp_ne_u32 vcc, v5, v10
    s_nop 0
    s_and_b32 vcc_lo, vcc_lo, 0x00030003
    s_and_b32 vcc_hi, vcc_hi, 0x00030003
    s_or_b64 vcc, vcc, s[90:91]
    s_or_b64 vcc, vcc, s[92:93]
    s_cbranch_scc1 L_slow1
L_ok1:
    s_mov_b32 s70, s69
    s_waitcnt vmcnt(5)
    buffer_load_dwordx4 a[0:3], v9, s[36:39], s70 offen nt
    v_and_b32 v48, 0xffffff00, v48
    v_and_b32 v49, 0xffffff00, v49
    v_and_b32 v50, 0xffffff00, v50
    v_and_b32 v51, 0xffffff00, v51
    v_and_b32 v52, 0xffffff00, v52
    v_and_b32 v53, 0xffffff00, v53
    v_and_b32 v54, 0xffffff00, v54
    v_and_b32 v55, 0xffffff00, v55
    v_and_b32 v56, 0xffffff00, v56
    v_and_b32 v57, 0xffffff00, v57
    v_and_b32 v58, 0xffffff00, v58
    v_and_b32 v59, 0xffffff00, v59
    v_permlane32_swap_b32 v48, v50
    v_permlane32_swap_b32 v49, v51
    v_add_f32 v48, v48, v50
    v_add_f32 v49, v49, v51
    s_nop 1
    v_permlane16_swap_b32 v48, v49
    v_add_f32 v48, v48, v49
    v_permlane32_swap_b32 v52, v54
    v_permlane32_swap_b32 v53, v55
    v_add_f32 v52, v52, v54
    v_add_f32 v53, v53, v55
    s_nop 1
    v_permlane16_swap_b32 v52, v53
    v_add_f32 v52, v52, v53
    v_permlane32_swap_b32 v56, v58
    v_permlane32_swap_b32 v57, v59
    v_add_f32 v56, v56, v58
    v_add_f32 v57, v57, v59
    s_nop 1
    v_permlane16_swap_b32 v56, v57
    v_add_f32 v56, v56, v57
    v_cvt_pk_bf16_f32 v48, v48, v48
    ds_write_b16 v17, v48
    s_lshl2_add_u32 s72, s3, 134016
    v_mov_b32 v7, s72
    v_mov_b32 v8, s22
    ds_write_b32 v7, v8
    v_cvt_pk_bf16_f32 v5, v52, v56
    v_lshlrev_b32 v52, 16, v5
    v_and_b32 v56, 0xffff0000, v5
    v_mul_f32 v53, 0xbfb8aa3b, v52
    v_mul_f32 v57, 0xbfb8aa3b, v56
    v_exp_f32 v53, v53
    v_exp_f32 v57, v57
    v_add_f32 v53, 1.0, v53
    v_add_f32 v57, 1.0, v57
    v_rcp_f32 v53, v53
    v_rcp_f32 v57, v57
    v_mul_f32 v52, v52, v53
    v_mul_f32 v56, v56, v57
    v_cvt_pk_bf16_f32 v5, v52, v56
    ds_write_b16 v26, v5
    s_mov_b32 exec_lo, 0x000f000f
    s_mov_b32 exec_hi, 0x000f000f
    ds_write_b16_d16_hi v26, v5 offset:128
    s_mov_b64 exec, -1
    s_add_u32 s70, s70, 0xd000
    s_and_b32 s70, s70, 0x73000
    s_waitcnt vmcnt(5)
    buffer_load_dwordx4 a[4:7], v9, s[36:39], s70 offen nt
    s_waitcnt lgkmcnt(0)
    s_barrier
    v_mov_b32 v7, 134016
    ds_read_b128 v[48:51], v7
    ds_read_b128 v[64:67], v27 offset:0
    ds_read_b128 v[68:71], v27 offset:64
    ds_read_b128 v[72:75], v27 offset:128
    ds_read_b128 v[76:79], v27 offset:192
    ds_read_b128 v[80:83], v28 offset:0
    ds_read_b128 v[84:87], v29 offset:0
    ds_read_b128 v[88:91], v30 offset:0
    ds_read_b128 v[92:95], v31 offset:0
    ds_read_b128 v[96:99], v28 offset:16384
    ds_read_b128 v[100:103], v29 offset:16384
    ds_read_b128 v[104:107], v30 offset:16384
    ds_read_b128 v[108:111], v31 offset:16384
    s_waitcnt lgkmcnt(4)
    v_mfma_f32_16x16x32_bf16 v[112:115], v[80:83], v[64:67], 0
    v_mfma_f32_16x16x32_bf16 v[112:115], v[84:87], v[68:71], v[112:115]
    s_add_u32 s70, s70, 0xd000
    s_and_b32 s70, s70, 0x73000
    s_waitcnt vmcnt(6)
    buffer_load_dwordx4 a[8:11], v9, s[36:39], s70 offen nt
    v_mfma_f32_16x16x32_bf16 v[112:115], v[88:91], v[72:75], v[112:115]
    v_mfma_f32_16x16x32_bf16 v[112:115], v[92:95], v[76:79], v[112:115]
    s_nop 3
    v_or3_b32 v7, v48, v49, v50
    v_or_b32 v7, v7, v51
    s_nop 0
    v_readfirstlane_b32 s22, v7
    s_nop 0
    s_cmp_lg_u32 s22, 0
    s_cbranch_scc1 L_mode1
L_mode1b:
    ds_read_b128 v[80:83], v28 offset:32768
    ds_read_b128 v[84:87], v29 offset:32768
    ds_read_b128 v[88:91], v30 offset:32768
    ds_read_b128 v[92:95], v31 offset:32768
    s_waitcnt lgkmcnt(4)
    v_mfma_f32_16x16x32_bf16 v[116:119], v[96:99], v[64:67], 0
    v_mfma_f32_16x16x32_bf16 v[116:119], v[100:103], v[68:71], v[116:119]
    v_mfma_f32_16x16x32_bf16 v[116:119], v[104:107], v[72:75], v[116:119]
    v_mfma_f32_16x16x32_bf16 v[116:119], v[108:111], v[76:79], v[116:119]
    s_nop 3
    ds_read_b128 v[96:99], v28 offset:49152
    ds_read_b128 v[100:103], v29 offset:49152
    ds_read_b128 v[104:107], v30 offset:49152
    ds_read_b128 v[108:111], v31 offset:49152
    s_waitcnt lgkmcnt(4)
    v_mfma_f32_16x16x32_bf16 v[120:123], v[80:83], v[64:67], 0
    s_add_u32 s70, s70, 0xd000
    s_and_b32 s70, s70, 0x73000
    s_waitcnt vmcnt(6)
    buffer_load_dwordx4 a[12:15], v9, s[36:39], s70 offen nt
    v_mfma_f32_16x16x32_bf16 v[120:123], v[84:87], v[68:71], v[120:123]
    v_mfma_f32_16x16x32_bf16 v[120:123], v[88:91], v[72:75], v[120:123]
    v_mfma_f32_16x16x32_bf16 v[120:123], v[92:95], v[76:79], v[120:123]
    s_nop 3
    v_add_u32 v28, 0x10000, v28
    v_add_u32 v29, 0x10000, v29
    v_add_u32 v30, 0x10000, v30
    v_add_u32 v31, 0x10000, v31
    ds_read_b128 v[80:83], v28 offset:0
    ds_read_b128 v[84:87], v29 offset:0
    ds_read_b128 v[88:91], v30 offset:0
    ds_read_b128 v[92:95], v31 offset:0
    s_waitcnt lgkmcnt(4)
    v_mfma_f32_16x16x32_bf16 v[124:127], v[96:99], v[64:67], 0
    v_mfma_f32_16x16x32_bf16 v[124:127], v[100:103], v[68:71], v[124:127]
    v_mfma_f32_16x16x32_bf16 v[124:127], v[104:107], v[72:75], v[124:127]
    v_mfma_f32_16x16x32_bf16 v[124:127], v[108:111], v[76:79], v[124:127]
    s_nop 3
    ds_read_b128 v[96:99], v28 offset:16384
    ds_read_b128 v[100:103], v29 offset:16384
    ds_read_b128 v[104:107], v30 offset:16384
    ds_read_b128 v[108:111], v31 offset:16384
    s_waitcnt lgkmcnt(4)
    v_mfma_f32_16x16x32_bf16 v[128:131], v[80:83], v[64:67], 0
    s_add_u32 s70, s70, 0xd000
    s_and_b32 s70, s70, 0x73000
    s_waitcnt vmcnt(6)
    buffer_load_dwordx4 a[16:19], v9, s[36:39], s70 offen nt
    v_mfma_f32_16x16x32_bf16 v[128:131], v[84:87], v[68:71], v[128:131]
    v_mfma_f32_16x16x32_bf16 v[128:131], v[88:91], v[72:75], v[128:131]
    v_mfma_f32_16x16x32_bf16 v[128:131], v[92:95], v[76:79], v[128:131]
    s_nop 3
    s_waitcnt vmcnt(9)
    ds_read_b128 v[80:83], v28 offset:32768
    ds_read_b128 v[84:87], v29 offset:32768
    ds_read_b128 v[88:91], v30 offset:32768
    ds_read_b128 v[92:95], v31 offset:32768
    s_waitcnt lgkmcnt(4)
    v_mfma_f32_16x16x32_bf16 v[132:135], v[96:99], v[64:67], 0
    v_mfma_f32_16x16x32_bf16 v[132:135], v[100:103], v[68:71], v[132:135]
    v_mfma_f32_16x16x32_bf16 v[132:135], v[104:107], v[72:75], v[132:135]
    v_mfma_f32_16x16x32_bf16 v[132:135], v[108:111], v[76:79], v[132:135]
    s_nop 3
    s_waitcnt vmcnt(5)
    ds_read_b128 v[96:99], v28 offset:49152
    ds_read_b128 v[100:103], v29 offset:49152
    ds_read_b128 v[104:107], v30 offset:49152
    ds_read_b128 v[108:111], v31 offset:49152
    s_waitcnt lgkmcnt(4)
    v_mfma_f32_16x16x32_bf16 v[136:139], v[80:83], v[64:67], 0
    s_add_u32 s70, s70, 0xd000
    s_and_b32 s70, s70, 0x73000
    s_waitcnt vmcnt(6)
    buffer_load_dwordx4 a[20:23], v9, s[36:39], s70 offen nt
    v_mfma_f32_16x16x32_bf16 v[136:139], v[84:87], v[68:71], v[136:139]
    v_mfma_f32_16x16x32_bf16 v[136:139], v[88:91], v[72:75], v[136:139]
    v_mfma_f32_16x16x32_bf16 v[136:139], v[92:95], v[76:79], v[136:139]
    s_nop 3
    s_waitcnt lgkmcnt(0)
    v_mfma_f32_16x16x32_bf16 v[140:143], v[96:99], v[64:67], 0
    v_mfma_f32_16x16x32_bf16 v[140:143], v[100:103], v[68:71], v[140:143]
    v_mfma_f32_16x16x32_bf16 v[140:143], v[104:107], v[72:75], v[140:143]
    v_mfma_f32_16x16x32_bf16 v[140:143], v[108:111], v[76:79], v[140:143]
    v_mov_b32 v22, 0x3db504f3
    v_cvt_pk_bf16_f32 v24, v112, v113
    v_cvt_pk_bf16_f32 v25, v114, v115
    v_cvt_pk_bf16_f32 v26, v116, v117
    v_cvt_pk_bf16_f32 v27, v118, v119
    v_cvt_pk_bf16_f32 v28, v120, v121
    v_cvt_pk_bf16_f32 v29, v122, v123
    v_cvt_pk_bf16_f32 v30, v124, v125
    v_cvt_pk_bf16_f32 v31, v126, v127
    v_and_b32 v113, 0xffff0000, v24
    v_lshlrev_b32 v112, 16, v24
    v_and_b32 v115, 0xffff0000, v25
    v_lshlrev_b32 v114, 16, v25
    v_and_b32 v117, 0xffff0000, v26
    v_lshlrev_b32 v116, 16, v26
    v_and_b32 v119, 0xffff0000, v27
    v_lshlrev_b32 v118, 16, v27
    v_and_b32 v121, 0xffff0000, v28
    v_lshlrev_b32 v120, 16, v28
    v_and_b32 v123, 0xffff0000, v29
    v_lshlrev_b32 v122, 16, v29
    v_and_b32 v125, 0xffff0000, v30
    v_lshlrev_b32 v124, 16, v30
    v_and_b32 v127, 0xffff0000, v31
    v_lshlrev_b32 v126, 16, v31
    v_pk_mul_f32 v[112:113], v[112:113], v[22:23] op_sel_hi:[1,0]
    v_pk_mul_f32 v[114:115], v[114:115], v[22:23] op_sel_hi:[1,0]
    v_pk_mul_f32 v[116:117], v[116:117], v[22:23] op_sel_hi:[1,0]
    s_add_u32 s70, s70, 0xd000
    s_and_b32 s70, s70, 0x73000
    s_waitcnt vmcnt(6)
    buffer_load_dwordx4 a[24:27], v9, s[36:39], s70 offen nt
    v_pk_mul_f32 v[118:119], v[118:119], v[22:23] op_sel_hi:[1,0]
    v_pk_mul_f32 v[120:121], v[120:121], v[22:23] op_sel_hi:[1,0]
    v_pk_mul_f32 v[122:123], v[122:123], v[22:23] op_sel_hi:[1,0]
    v_pk_mul_f32 v[124:125], v[124:125], v[22:23] op_sel_hi:[1,0]
    v_pk_mul_f32 v[126:127], v[126:127], v[22:23] op_sel_hi:[1,0]
    v_cvt_pk_bf16_f32 v24, v112, v113
    v_cvt_pk_bf16_f32 v25, v114, v115
    v_cvt_pk_bf16_f32 v26, v116, v117
    v_cvt_pk_bf16_f32 v27, v118, v119
    v_cvt_pk_bf16_f32 v28, v120, v121
    v_cvt_pk_bf16_f32 v29, v122, v123
    v_cvt_pk_bf16_f32 v30, v124, v125
    v_cvt_pk_bf16_f32 v31, v126, v127
    v_and_b32 v113, 0xffff0000, v24
    v_lshlrev_b32 v112, 16, v24
    v_and_b32 v115, 0xffff0000, v25
    v_lshlrev_b32 v114, 16, v25
    v_and_b32 v117, 0xffff0000, v26
    v_lshlrev_b32 v116, 16, v26
    v_and_b32 v119, 0xffff0000, v27
    v_lshlrev_b32 v118, 16, v27
    v_and_b32 v121, 0xffff0000, v28
    v_lshlrev_b32 v120, 16, v28
    v_and_b32 v123, 0xffff0000, v29
    v_lshlrev_b32 v122, 16, v29
    v_and_b32 v125, 0xffff0000, v30
    v_lshlrev_b32 v124, 16, v30
    v_and_b32 v127, 0xffff0000, v31
    v_lshlrev_b32 v126, 16, v31
    v_cvt_pk_bf16_f32 v24, v128, v129
    v_cvt_pk_bf16_f32 v25, v130, v131
    v_cvt_pk_bf16_f32 v26, v132, v133
    v_cvt_pk_bf16_f32 v27, v134, v135
    v_cvt_pk_bf16_f32 v28, v136, v137
    v_cvt_pk_bf16_f32 v29, v138, v139
    v_cvt_pk_bf16_f32 v30, v140, v141
    v_cvt_pk_bf16_f32 v31, v142, v143
    v_and_b32 v129, 0xffff0000, v24
    v_lshlrev_b32 v128, 16, v24
    v_and_b32 v131, 0xffff0000, v25
    v_lshlrev_b32 v130, 16, v25
    v_and_b32 v133, 0xffff0000, v26
    v_lshlrev_b32 v132, 16, v26
    v_and_b32 v135, 0xffff0000, v27
    v_lshlrev_b32 v134, 16, v27
    v_and_b32 v137, 0xffff0000, v28
    v_lshlrev_b32 v136, 16, v28
    v_and_b32 v139, 0xffff0000, v29
    v_lshlrev_b32 v138, 16, v29
    v_and_b32 v141, 0xffff0000, v30
    v_lshlrev_b32 v140, 16, v30
    v_and_b32 v143, 0xffff0000, v31
    v_lshlrev_b32 v142, 16, v31
    v_pk_mul_f32 v[128:129], v[128:129], v[22:23] op_sel_hi:[1,0]
    v_pk_mul_f32 v[130:131], v[130:131], v[22:23] op_sel_hi:[1,0]
    v_pk_mul_f32 v[132:133], v[132:133], v[22:23] op_sel_hi:[1,0]
    v_pk_mul_f32 v[134:135], v[134:135], v[22:23] op_sel_hi:[1,0]
    v_pk_mul_f32 v[136:137], v[136:137], v[22:23] op_sel_hi:[1,0]
    v_pk_mul_f32 v[138:139], v[138:139], v[22:23] op_sel_hi:[1,0]
    v_pk_mul_f32 v[140:141], v[140:141], v[22:23] op_sel_hi:[1,0]
    v_pk_mul_f32 v[142:143], v[142:143], v[22:23] op_sel_hi:[1,0]
    v_cvt_pk_bf16_f32 v24, v128, v129
    s_add_u32 s70, s70, 0xd000
    s_and_b32 s70, s70, 0x73000
    s_waitcnt vmcnt(6)
    buffer_load_dwordx4 a[28:31], v9, s[36:39], s70 offen nt
    v_cvt_pk_bf16_f32 v25, v130, v131
    v_cvt_pk_bf16_f32 v26, v132, v133
    v_cvt_pk_bf16_f32 v27, v134, v135
    v_cvt_pk_bf16_f32 v28, v136, v137
    v_cvt_pk_bf16_f32 v29, v138, v139
    v_cvt_pk_bf16_f32 v30, v140, v141
    v_cvt_pk_bf16_f32 v31, v142, v143
    v_and_b32 v129, 0xffff0000, v24
    v_lshlrev_b32 v128, 16, v24
    v_and_b32 v131, 0xffff0000, v25
    v_lshlrev_b32 v130, 16, v25
    v_and_b32 v133, 0xffff0000, v26
    v_lshlrev_b32 v132, 16, v26
    v_and_b32 v135, 0xffff0000, v27
    v_lshlrev_b32 v134, 16, v27
    v_and_b32 v137, 0xffff0000, v28
    v_lshlrev_b32 v136, 16, v28
    v_and_b32 v139, 0xffff0000, v29
    v_lshlrev_b32 v138, 16, v29
    v_and_b32 v141, 0xffff0000, v30
    v_lshlrev_b32 v140, 16, v30
    v_and_b32 v143, 0xffff0000, v31
    v_lshlrev_b32 v142, 16, v31
    v_max_f32 v46, v112, v113
    v_max3_f32 v46, v114, v115, v46
    v_max3_f32 v46, v116, v117, v46
    v_max3_f32 v46, v118, v119, v46
    v_max3_f32 v46, v120, v121, v46
    v_max3_f32 v46, v122, v123, v46
    v_max3_f32 v46, v124, v125, v46
    v_max3_f32 v46, v126, v127, v46
    v_max3_f32 v46, v128, v129, v46
    v_max3_f32 v46, v130, v131, v46
    v_max3_f32 v46, v132, v133, v46
    v_max3_f32 v46, v134, v135, v46
    v_max3_f32 v46, v136, v137, v46
    v_max3_f32 v46, v138, v139, v46
    v_max3_f32 v46, v140, v141, v46
    v_max3_f32 v46, v142, v143, v46
    v_mov_b32 v5, v46
    s_nop 1
    v_permlane16_swap_b32 v46, v5
    v_max_f32 v46, v46, v5
    v_mov_b32 v5, v46
    s_nop 1
    v_permlane32_swap_b32 v46, v5
    v_max_f32 v46, v46, v5
    v_mov_b32 v22, 0x3fb8aa3b
    v_pk_add_f32 v[112:113], v[112:113], v[46:47] op_sel_hi:[1,0] neg_lo:[0,1] neg_hi:[0,1]
    v_pk_add_f32 v[114:115], v[114:115], v[46:47] op_sel_hi:[1,0] neg_lo:[0,1] neg_hi:[0,1]
    v_pk_add_f32 v[116:117], v[116:117], v[46:47] op_sel_hi:[1,0] neg_lo:[0,1] neg_hi:[0,1]
    v_pk_add_f32 v[118:119], v[118:119], v[46:47] op_sel_hi:[1,0] neg_lo:[0,1] neg_hi:[0,1]
    v_pk_add_f32 v[120:121], v[120:121], v[46:47] op_sel_hi:[1,0] neg_lo:[0,1] neg_hi:[0,1]
    v_pk_add_f32 v[122:123], v[122:123], v[46:47] op_sel_hi:[1,0] neg_lo:[0,1] neg_hi:[0,1]
    v_pk_add_f32 v[124:125], v[124:125], v[46:47] op_sel_hi:[1,0] neg_lo:[0,1] neg_hi:[0,1]
    v_pk_add_f32 v[126:127], v[126:127], v[46:47] op_sel_hi:[1,0] neg_lo:[0,1] neg_hi:[0,1]
    v_pk_add_f32 v[128:129], v[128:129], v[46:47] op_sel_hi:[1,0] neg_lo:[0,1] neg_hi:[0,1]
    v_pk_add_f32 v[130:131], v[130:131], v[46:47] op_sel_hi:[1,0] neg_lo:[0,1] neg_hi:[0,1]
    v_pk_add_f32 v[132:133], v[132:133], v[46:47] op_sel_hi:[1,0] neg_lo:[0,1] neg_hi:[0,1]
    v_pk_add_f32 v[134:135], v[134:135], v[46:47] op_sel_hi:[1,0] neg_lo:[0,1] neg_hi:[0,1]
    v_pk_add_f32 v[136:137], v[136:137], v[46:47] op_sel_hi:[1,0] neg_lo:[0,1] neg_hi:[0,1]
    v_pk_add_f32 v[138:139], v[138:139], v[46:47] op_sel_hi:[1,0] neg_lo:[0,1] neg_hi:[0,1]
    s_add_u32 s70, s70, 0xd000
    s_and_b32 s70, s70, 0x73000
    s_waitcnt vmcnt(6)
    buffer_load_dwordx4 a[32:35], v9, s[36:39], s70 offen nt
    v_pk_add_f32 v[140:141], v[140:141], v[46:47] op_sel_hi:[1,0] neg_lo:[0,1] neg_hi:[0,1]
    v_pk_add_f32 v[142:143], v[142:143], v[46:47] op_sel_hi:[1,0] neg_lo:[0,1] neg_hi:[0,1]
    v_pk_mul_f32 v[112:113], v[112:113], v[22:23] op_sel_hi:[1,0]
    v_pk_mul_f32 v[114:115], v[114:115], v[22:23] op_sel_hi:[1,0]
    v_pk_mul_f32 v[116:117], v[116:117], v[22:23] op_sel_hi:[1,0]
    v_pk_mul_f32 v[118:119], v[118:119], v[22:23] op_sel_hi:[1,0]
    v_pk_mul_f32 v[120:121], v[120:121], v[22:23] op_sel_hi:[1,0]
    v_pk_mul_f32 v[122:123], v[122:123], v[22:23] op_sel_hi:[1,0]
    v_pk_mul_f32 v[124:125], v[124:125], v[22:23] op_sel_hi:[1,0]
    v_pk_mul_f32 v[126:127], v[126:127], v[22:23] op_sel_hi:[1,0]
    v_pk_mul_f32 v[128:129], v[128:129], v[22:23] op_sel_hi:[1,0]
    v_pk_mul_f32 v[130:131], v[130:131], v[22:23] op_sel_hi:[1,0]
    v_pk_mul_f32 v[132:133], v[132:133], v[22:23] op_sel_hi:[1,0]
    v_pk_mul_f32 v[134:135], v[134:135], v[22:23] op_sel_hi:[1,0]
    v_pk_mul_f32 v[136:137], v[136:137], v[22:23] op_sel_hi:[1,0]
    v_pk_mul_f32 v[138:139], v[138:139], v[22:23] op_sel_hi:[1,0]
    v_pk_mul_f32 v[140:141], v[140:141], v[22:23] op_sel_hi:[1,0]
    v_pk_mul_f32 v[142:143], v[142:143], v[22:23] op_sel_hi:[1,0]
    v_exp_f32 v112, v112
    v_exp_f32 v113, v113
    v_exp_f32 v114, v114
    v_exp_f32 v115, v115
    v_exp_f32 v116, v116
    v_exp_f32 v117, v117
    v_exp_f32 v118, v118
    v_exp_f32 v119, v119
    v_exp_f32 v120, v120
    v_exp_f32 v121, v121
    v_exp_f32 v122, v122
    v_exp_f32 v123, v123
    v_exp_f32 v124, v124
    v_exp_f32 v125, v125
    v_exp_f32 v126, v126
    v_exp_f32 v127, v127
    v_exp_f32 v128, v128
    v_exp_f32 v129, v129
    v_exp_f32 v130, v130
    v_exp_f32 v131, v131
    s_add_u32 s70, s70, 0xd000
    s_and_b32 s70, s70, 0x73000
    s_waitcnt vmcnt(6)
    buffer_load_dwordx4 a[36:39], v9, s[36:39], s70 offen nt
    v_exp_f32 v132, v132
    v_exp_f32 v133, v133
    v_exp_f32 v134, v134
    v_exp_f32 v135, v135
    v_exp_f32 v136, v136
    v_exp_f32 v137, v137
    v_exp_f32 v138, v138
    v_exp_f32 v139, v139
    v_exp_f32 v140, v140
    v_exp_f32 v141, v141
    v_exp_f32 v142, v142
    v_exp_f32 v143, v143
    v_pk_add_f32 v[48:49], v[112:113], v[114:115]
    v_pk_add_f32 v[48:49], v[48:49], v[116:117]
    v_pk_add_f32 v[48:49], v[48:49], v[118:119]
    v_pk_add_f32 v[48:49], v[48:49], v[120:121]
    v_pk_add_f32 v[48:49], v[48:49], v[122:123]
    v_pk_add_f32 v[48:49], v[48:49], v[124:125]
    v_pk_add_f32 v[48:49], v[48:49], v[126:127]
    v_pk_add_f32 v[48:49], v[48:49], v[128:129]
    v_pk_add_f32 v[48:49], v[48:49], v[130:131]
    v_pk_add_f32 v[48:49], v[48:49], v[132:133]
    v_pk_add_f32 v[48:49], v[48:49], v[134:135]
    v_pk_add_f32 v[48:49], v[48:49], v[136:137]
    v_pk_add_f32 v[48:49], v[48:49], v[138:139]
    v_pk_add_f32 v[48:49], v[48:49], v[140:141]
    v_pk_add_f32 v[48:49], v[48:49], v[142:143]
    v_add_f32 v47, v48, v49
    v_mov_b32 v5, v47
    s_nop 1
    v_permlane16_swap_b32 v47, v5
    v_add_f32 v47, v47, v5
    v_mov_b32 v5, v47
    s_nop 1
    v_permlane32_swap_b32 v47, v5
    v_add_f32 v47, v47, v5
    s_lshl_b32 s72, s3, 4
    s_add_u32 s72, s72, 133376
    v_and_b32 v5, 8, v4
    v_add_u32 v5, s72, v5
    ds_write_b64 v5, v[46:47]
    v_cvt_pk_bf16_f32 v112, v112, v112
    v_cvt_pk_bf16_f32 v113, v113, v113
    v_cvt_pk_bf16_f32 v114, v114, v114
    v_cvt_pk_bf16_f32 v115, v115, v115
    v_cvt_pk_bf16_f32 v116, v116, v116
    v_cvt_pk_bf16_f32 v117, v117, v117
    s_add_u32 s70, s70, 0xd000
    s_and_b32 s70, s70, 0x73000
    s_waitcnt vmcnt(6)
    buffer_load_dwordx4 a[40:43], v9, s[36:39], s70 offen nt
    v_cvt_pk_bf16_f32 v118, v118, v118
    v_cvt_pk_bf16_f32 v119, v119, v119
    v_cvt_pk_bf16_f32 v120, v120, v120
    v_cvt_pk_bf16_f32 v121, v121, v121
    v_cvt_pk_bf16_f32 v122, v122, v122
    v_cvt_pk_bf16_f32 v123, v123, v123
    v_cvt_pk_bf16_f32 v124, v124, v124
    v_cvt_pk_bf16_f32 v125, v125, v125
    v_cvt_pk_bf16_f32 v126, v126, v126
    v_cvt_pk_bf16_f32 v127, v127, v127
    v_cvt_pk_bf16_f32 v128, v128, v128
    v_cvt_pk_bf16_f32 v129, v129, v129
    v_cvt_pk_bf16_f32 v130, v130, v130
    v_cvt_pk_bf16_f32 v131, v131, v131
    v_cvt_pk_bf16_f32 v132, v132, v132
    v_cvt_pk_bf16_f32 v133, v133, v133
    v_cvt_pk_bf16_f32 v134, v134, v134
    v_cvt_pk_bf16_f32 v135, v135, v135
    v_cvt_pk_bf16_f32 v136, v136, v136
    v_cvt_pk_bf16_f32 v137, v137, v137
    v_cvt_pk_bf16_f32 v138, v138, v138
    v_cvt_pk_bf16_f32 v139, v139, v139
    v_cvt_pk_bf16_f32 v140, v140, v140
    v_cvt_pk_bf16_f32 v141, v141, v141
    v_cvt_pk_bf16_f32 v142, v142, v142
    v_cvt_pk_bf16_f32 v143, v143, v143
    s_waitcnt lgkmcnt(0)
    s_barrier
    v_lshrrev_b32 v5, 5, v4
    v_lshlrev_b32 v5, 3, v5
    v_add_u32 v6, s72, v5
    v_add_u32 v5, 133376, v5
    ds_read_b64 v[24:25], v5 offset:0
    ds_read_b64 v[26:27], v5 offset:16
    ds_read_b64 v[28:29], v5 offset:32
    ds_read_b64 v[30:31], v5 offset:48
    ds_read_b32 v48, v6
    s_waitcnt lgkmcnt(0)
    v_max3_f32 v52, v24, v26, v28
    s_add_u32 s70, s70, 0xd000
    s_and_b32 s70, s70, 0x73000
    s_waitcnt vmcnt(6)
    buffer_load_dwordx4 a[44:47], v9, s[36:39], s70 offen nt
    v_max_f32 v52, v52, v30
    v_sub_f32 v24, v24, v52
    v_sub_f32 v26, v26, v52
    v_sub_f32 v28, v28, v52
    v_sub_f32 v30, v30, v52
    v_sub_f32 v48, v48, v52
    v_mul_f32 v24, 0x3fb8aa3b, v24
    v_mul_f32 v26, 0x3fb8aa3b, v26
    v_mul_f32 v28, 0x3fb8aa3b, v28
    v_mul_f32 v30, 0x3fb8aa3b, v30
    v_mul_f32 v48, 0x3fb8aa3b, v48
    v_exp_f32 v24, v24
    v_exp_f32 v26, v26
    v_exp_f32 v28, v28
    v_exp_f32 v30, v30
    v_exp_f32 v50, v48
    v_mul_f32 v53, v24, v25
    v_fmac_f32 v53, v26, v27
    v_fmac_f32 v53, v28, v29
    v_fmac_f32 v53, v30, v31
    v_mov_b32 v54, v52
    v_mov_b32 v55, v53
    s_nop 0
    v_permlane32_swap_b32 v52, v54
    v_permlane32_swap_b32 v53, v55
    v_perm_b32 v52, v52, v12, s76
    v_perm_b32 v53, v53, v12, s77
    v_perm_b32 v54, v54, v12, s78
    v_perm_b32 v55, v55, v12, s79
    s_mul_i32 s72, s68, 2304
    s_add_u32 s73, s72, 6272
    v_cmp_gt_u32 vcc, 8, v0
    v_mov_b32 v5, 0x40000000
    v_lshl_add_u32 v6, v0, 4, s73
    v_cndmask_b32 v5, v5, v6, vcc
    s_cmp_lg_u32 s22, 0
    s_cbranch_scc1 L_altm
    buffer_store_dwordx4 v[52:55], v5, s[56:59], 0 offen
L_altbm:
    v_and_b32 v93, 0xffff0000, v44
    v_lshlrev_b32 v92, 16, v44
    v_and_b32 v95, 0xffff0000, v45
    v_lshlrev_b32 v94, 16, v45
    v_and_b32 v56, v112, v18
    v_and_b32 v57, v112, v19
    v_and_b32 v58, v112, v20
    v_and_b32 v59, v112, v21
    v_and_b32 v60, v113, v18
    v_and_b32 v61, v113, v19
    v_and_b32 v62, v113, v20
    v_and_b32 v63, v113, v21
    s_add_u32 s70, s70, 0xd000
    s_and_b32 s70, s70, 0x73000
    s_waitcnt vmcnt(6)
    buffer_load_dwordx4 a[48:51], v9, s[36:39], s70 offen nt
    s_waitcnt vmcnt(12)
    v_mfma_f32_16x16x32_bf16 v[24:27], v[56:59], a[0:3], 0
    v_and_b32 v64, v114, v18
    v_and_b32 v65, v114, v19
    v_and_b32 v66, v114, v20
    v_and_b32 v67, v114, v21
    s_waitcnt vmcnt(11)
    v_mfma_f32_16x16x32_bf16 v[24:27], v[60:63], a[4:7], v[24:27]
    v_and_b32 v68, v115, v18
    v_and_b32 v69, v115, v19
    v_and_b32 v70, v115, v20
    v_and_b32 v71, v115, v21
    s_waitcnt vmcnt(10)
    v_mfma_f32_16x16x32_bf16 v[24:27], v[64:67], a[8:11], v[24:27]
    v_and_b32 v72, v116, v18
    v_and_b32 v73, v116, v19
    v_and_b32 v74, v116, v20
    v_and_b32 v75, v116, v21
    s_waitcnt vmcnt(9)
    v_mfma_f32_16x16x32_bf16 v[24:27], v[68:71], a[12:15], v[24:27]
    v_and_b32 v76, v117, v18
    v_and_b32 v77, v117, v19
    v_and_b32 v78, v117, v20
    v_and_b32 v79, v117, v21
    s_add_u32 s70, s70, 0xd000
    s_and_b32 s70, s70, 0x73000
    s_waitcnt vmcnt(6)
    buffer_load_dwordx4 a[52:55], v9, s[36:39], s70 offen nt
    s_waitcnt vmcnt(9)
    v_mfma_f32_16x16x32_bf16 v[24:27], v[72:75], a[16:19], v[24:27]
    v_and_b32 v80, v118, v18
    v_and_b32 v81, v118, v19
    v_and_b32 v82, v118, v20
    v_and_b32 v83, v118, v21
    s_waitcnt vmcnt(8)
    v_mfma_f32_16x16x32_bf16 v[24:27], v[76:79], a[20:23], v[24:27]
    v_and_b32 v84, v119, v18
    v_and_b32 v85, v119, v19
    v_and_b32 v86, v119, v20
    v_and_b32 v87, v119, v21
    s_waitcnt vmcnt(7)
    v_mfma_f32_16x16x32_bf16 v[24:27], v[80:83], a[24:27], v[24:27]
    v_and_b32 v56, v120, v18
    v_and_b32 v57, v120, v19
    v_and_b32 v58, v120, v20
    v_and_b32 v59, v120, v21
    s_add_u32 s70, s70, 0xd000
    s_and_b32 s70, s70, 0x73000
    s_waitcnt vmcnt(6)
    buffer_load_dwordx4 a[56:59], v9, s[36:39], s70 offen nt
    s_waitcnt vmcnt(7)
    v_mfma_f32_16x16x32_bf16 v[24:27], v[84:87], a[28:31], v[24:27]
    v_and_b32 v60, v121, v18
    v_and_b32 v61, v121, v19
    v_and_b32 v62, v121, v20
    v_and_b32 v63, v121, v21
    s_add_u32 s70, s70, 0xd000
    s_and_b32 s70, s70, 0x73000
    s_waitcnt vmcnt(6)
    buffer_load_dwordx4 a[60:63], v9, s[36:39], s70 offen nt
    s_waitcnt vmcnt(7)
    v_mfma_f32_16x16x32_bf16 v[24:27], v[56:59], a[32:35], v[24:27]
    v_and_b32 v64, v122, v18
    v_and_b32 v65, v122, v19
    v_and_b32 v66, v122, v20
    v_and_b32 v67, v122, v21
    s_add_u32 s70, s70, 0xd000
    s_and_b32 s70, s70, 0x73000
    s_waitcnt vmcnt(6)
    buffer_load_dwordx4 a[64:67], v9, s[36:39], s70 offen nt
    s_waitcnt vmcnt(7)
    v_mfma_f32_16x16x32_bf16 v[24:27], v[60:63], a[36:39], v[24:27]
    v_and_b32 v68, v123, v18
    v_and_b32 v69, v123, v19
    v_and_b32 v70, v123, v20
    v_and_b32 v71, v123, v21
    s_add_u32 s70, s70, 0xd000
    s_and_b32 s70, s70, 0x73000
    s_waitcnt vmcnt(6)
    buffer_load_dwordx4 a[68:71], v9, s[36:39], s70 offen nt
    s_waitcnt vmcnt(7)
    v_mfma_f32_16x16x32_bf16 v[24:27], v[64:67], a[40:43], v[24:27]
    v_and_b32 v72, v124, v18
    v_and_b32 v73, v124, v19
    v_and_b32 v74, v124, v20
    v_and_b32 v75, v124, v21
    s_add_u32 s70, s70, 0xd000
    s_and_b32 s70, s70, 0x73000
    s_waitcnt vmcnt(5)
    buffer_load_dwordx4 a[72:75], v9, s[36:39], s70 offen nt
    buffer_load_dwordx4 v[88:91], v36, s[56:59], 0 offen sc1
    s_waitcnt vmcnt(8)
    v_mfma_f32_16x16x32_bf16 v[24:27], v[68:71], a[44:47], v[24:27]
    v_and_b32 v76, v125, v18
    v_and_b32 v77, v125, v19
    v_and_b32 v78, v125, v20
    v_and_b32 v79, v125, v21
    s_add_u32 s70, s70, 0xd000
    s_and_b32 s70, s70, 0x73000
    s_waitcnt vmcnt(6)
    buffer_load_dwordx4 a[76:79], v9, s[36:39], s70 offen nt
    s_waitcnt vmcnt(8)
    v_mfma_f32_16x16x32_bf16 v[24:27], v[72:75], a[48:51], v[24:27]
    v_and_b32 v80, v126, v18
    v_and_b32 v81, v126, v19
    v_and_b32 v82, v126, v20
    v_and_b32 v83, v126, v21
    s_add_u32 s70, s70, 0xd000
    s_and_b32 s70, s70, 0x73000
    s_waitcnt vmcnt(6)
    buffer_load_dwordx4 a[80:83], v9, s[36:39], s70 offen nt
    s_waitcnt vmcnt(8)
    v_mfma_f32_16x16x32_bf16 v[24:27], v[76:79], a[52:55], v[24:27]
    v_and_b32 v84, v127, v18
    v_and_b32 v85, v127, v19
    v_and_b32 v86, v127, v20
    v_and_b32 v87, v127, v21
    s_add_u32 s70, s70, 0xd000
    s_and_b32 s70, s70, 0x73000
    s_waitcnt vmcnt(6)
    buffer_load_dwordx4 a[84:87], v9, s[36:39], s70 offen nt
    s_waitcnt vmcnt(8)
    v_mfma_f32_16x16x32_bf16 v[24:27], v[80:83], a[56:59], v[24:27]
    v_and_b32 v56, v128, v18
    v_and_b32 v57, v128, v19
    v_and_b32 v58, v128, v20
    v_and_b32 v59, v128, v21
    s_add_u32 s70, s70, 0xd000
    s_and_b32 s70, s70, 0x73000
    s_waitcnt vmcnt(6)
    buffer_load_dwordx4 a[88:91], v9, s[36:39], s70 offen nt
    s_waitcnt vmcnt(8)
    v_mfma_f32_16x16x32_bf16 v[24:27], v[84:87], a[60:63], v[24:27]
    v_and_b32 v60, v129, v18
    v_and_b32 v61, v129, v19
    v_and_b32 v62, v129, v20
    v_and_b32 v63, v129, v21
    s_add_u32 s70, s70, 0xd000
    s_and_b32 s70, s70, 0x73000
    s_waitcnt vmcnt(6)
    buffer_load_dwordx4 a[92:95], v9, s[36:39], s70 offen nt
    s_waitcnt vmcnt(8)
    v_mfma_f32_16x16x32_bf16 v[24:27], v[56:59], a[64:67], v[24:27]
    v_and_b32 v64, v130, v18
    v_and_b32 v65, v130, v19
    v_and_b32 v66, v130, v20
    v_and_b32 v67, v130, v21
    s_add_u32 s70, s70, 0xd000
    s_and_b32 s70, s70, 0x73000
    s_waitcnt vmcnt(6)
    buffer_load_dwordx4 a[96:99], v9, s[36:39], s70 offen nt
    s_waitcnt vmcnt(8)
    v_mfma_f32_16x16x32_bf16 v[24:27], v[60:63], a[68:71], v[24:27]
    v_and_b32 v68, v131, v18
    v_and_b32 v69, v131, v19
    v_and_b32 v70, v131, v20
    v_and_b32 v71, v131, v21
    s_add_u32 s70, s70, 0xd000
    s_and_b32 s70, s70, 0x73000
    s_waitcnt vmcnt(5)
    buffer_load_dwordx4 a[100:103], v9, s[36:39], s70 offen nt
    s_waitcnt vmcnt(8)
    v_mfma_f32_16x16x32_bf16 v[24:27], v[64:67], a[72:75], v[24:27]
    s_waitcnt vmcnt(7)
L_chk2:
    v_perm_b32 v5, v89, v88, s80
    v_perm_b32 v6, v91, v90, s81
    v_or_b32 v5, v5, v6
    v_cmp_ne_u32 vcc, v5, v12
    s_cbranch_vccnz L_slow2
    s_cmp_ge_u32 s66, 2
    s_cselect_b64 vcc, -1, 0
    v_cndmask_b32 v7, v88, v90, vcc
    v_cndmask_b32 v8, v89, v91, vcc
    v_and_b32 v7, 0xffffff00, v7
    v_and_b32 v8, 0xffffff00, v8
    v_mov_b32 v22, v7
    v_mov_b32 v5, v22
    s_nop 1
    v_permlane16_swap_b32 v22, v5
    v_max_f32 v22, v22, v5
    v_mov_b32 v5, v22
    s_nop 1
    v_permlane32_swap_b32 v22, v5
    v_max_f32 v22, v22, v5
    v_sub_f32 v7, v7, v22
    v_mul_f32 v7, 0x3fb8aa3b, v7
    v_exp_f32 v7, v7
    s_nop 0
    v_mul_f32 v8, v7, v8
    v_mov_b32 v5, v8
    s_nop 1
    v_permlane16_swap_b32 v8, v5
    v_add_f32 v8, v8, v5
    v_mov_b32 v5, v8
    s_nop 1
    v_permlane32_swap_b32 v8, v5
    v_add_f32 v8, v8, v5
    v_rcp_f32 v8, v8
    s_nop 0
    v_mul_f32 v22, v7, v8
    v_and_b32 v72, v132, v18
    v_and_b32 v73, v132, v19
    v_and_b32 v74, v132, v20
    v_and_b32 v75, v132, v21
    s_add_u32 s70, s70, 0xd000
    s_and_b32 s70, s70, 0x73000
    s_waitcnt vmcnt(5)
    buffer_load_dwordx4 a[104:107], v9, s[36:39], s70 offen nt
    s_waitcnt vmcnt(7)
    v_mfma_f32_16x16x32_bf16 v[24:27], v[68:71], a[76:79], v[24:27]
    v_and_b32 v76, v133, v18
    v_and_b32 v77, v133, v19
    v_and_b32 v78, v133, v20
    v_and_b32 v79, v133, v21
    s_add_u32 s70, s70, 0xd000
    s_and_b32 s70, s70, 0x73000
    s_waitcnt vmcnt(5)
    buffer_load_dwordx4 a[108:111], v9, s[36:39], s70 offen nt
    s_waitcnt vmcnt(7)
    v_mfma_f32_16x16x32_bf16 v[24:27], v[72:75], a[80:83], v[24:27]
    v_and_b32 v80, v134, v18
    v_and_b32 v81, v134, v19
    v_and_b32 v82, v134, v20
    v_and_b32 v83, v134, v21
    s_add_u32 s70, s70, 0xd000
    s_and_b32 s70, s70, 0x73000
    s_waitcnt vmcnt(5)
    buffer_load_dwordx4 a[112:115], v9, s[36:39], s70 offen nt
    s_waitcnt vmcnt(7)
    v_mfma_f32_16x16x32_bf16 v[24:27], v[76:79], a[84:87], v[24:27]
    v_and_b32 v84, v135, v18
    v_and_b32 v85, v135, v19
    v_and_b32 v86, v135, v20
    v_and_b32 v87, v135, v21
    s_add_u32 s70, s70, 0xd000
    s_and_b32 s70, s70, 0x73000
    s_waitcnt vmcnt(5)
    buffer_load_dwordx4 a[116:119], v9, s[36:39], s70 offen nt
    s_waitcnt vmcnt(7)
    v_mfma_f32_16x16x32_bf16 v[24:27], v[80:83], a[88:91], v[24:27]
    v_and_b32 v56, v136, v18
    v_and_b32 v57, v136, v19
    v_and_b32 v58, v136, v20
    v_and_b32 v59, v136, v21
    s_add_u32 s70, s70, 0xd000
    s_and_b32 s70, s70, 0x73000
    s_waitcnt vmcnt(5)
    buffer_load_dwordx4 a[120:123], v9, s[36:39], s70 offen nt
    s_waitcnt vmcnt(7)
    v_mfma_f32_16x16x32_bf16 v[24:27], v[84:87], a[92:95], v[24:27]
    v_and_b32 v60, v137, v18
    v_and_b32 v61, v137, v19
    v_and_b32 v62, v137, v20
    v_and_b32 v63, v137, v21
    s_add_u32 s70, s70, 0xd000
    s_and_b32 s70, s70, 0x73000
    s_waitcnt vmcnt(5)
    buffer_load_dwordx4 a[124:127], v9, s[36:39], s70 offen nt
    s_waitcnt vmcnt(7)
    v_mfma_f32_16x16x32_bf16 v[24:27], v[56:59], a[96:99], v[24:27]
    v_and_b32 v64, v138, v18
    v_and_b32 v65, v138, v19
    v_and_b32 v66, v138, v20
    v_and_b32 v67, v138, v21
    v_lshlrev_b32 v17, 4, v0
    v_mul_u32_u24 v43, 3641, v0
    s_movk_i32 s87, 864
    v_lshrrev_b32 v46, 16, v43
    s_add_u32 m0, s88, 134144
    v_mad_u32_u24 v46, v46, s87, v17
    s_waitcnt vmcnt(5)
    buffer_load_dwordx4 v46, s[48:51], 0 offen nt lds
    v_and_b32 v68, v139, v18
    v_and_b32 v69, v139, v19
    v_and_b32 v70, v139, v20
    v_and_b32 v71, v139, v21
    v_and_b32 v72, v140, v18
    v_and_b32 v73, v140, v19
    v_and_b32 v74, v140, v20
    v_and_b32 v75, v140, v21
    v_and_b32 v76, v141, v18
    v_and_b32 v77, v141, v19
    v_and_b32 v78, v141, v20
    v_and_b32 v79, v141, v21
    v_and_b32 v80, v142, v18
    v_and_b32 v81, v142, v19
    v_and_b32 v82, v142, v20
    v_and_b32 v83, v142, v21
    v_and_b32 v84, v143, v18
    v_and_b32 v85, v143, v19
    v_and_b32 v86, v143, v20
    v_and_b32 v87, v143, v21
    s_waitcnt vmcnt(7)
    v_mfma_f32_16x16x32_bf16 v[24:27], v[60:63], a[100:103], v[24:27]
    v_add_u32 v17, 0x1000, v17
    v_add_u32 v43, 932096, v43
    s_movk_i32 s87, 864
    v_lshrrev_b32 v46, 16, v43
    s_add_u32 m0, s88, 138240
    v_mad_u32_u24 v46, v46, s87, v17
    s_waitcnt vmcnt(5)
    buffer_load_dwordx4 v46, s[48:51], 0 offen nt lds
    s_waitcnt vmcnt(7)
    v_mfma_f32_16x16x32_bf16 v[24:27], v[64:67], a[104:107], v[24:27]
    v_add_u32 v17, 0x1000, v17
    v_add_u32 v43, 932096, v43
    s_movk_i32 s87, 864
    v_lshrrev_b32 v46, 16, v43
    s_add_u32 m0, s88, 142336
    v_mad_u32_u24 v46, v46, s87, v17
    s_waitcnt vmcnt(5)
    buffer_load_dwordx4 v46, s[48:51], 0 offen nt lds
    s_waitcnt vmcnt(7)
    v_mfma_f32_16x16x32_bf16 v[24:27], v[68:71], a[108:111], v[24:27]
    v_add_u32 v17, 0x1000, v17
    v_add_u32 v43, 932096, v43
    s_movk_i32 s87, 864
    v_lshrrev_b32 v46, 16, v43
    s_add_u32 m0, s88, 146432
    v_mad_u32_u24 v46, v46, s87, v17
    s_waitcnt vmcnt(5)
    buffer_load_dwordx4 v46, s[48:51], 0 offen nt lds
    s_waitcnt vmcnt(7)
    v_mfma_f32_16x16x32_bf16 v[24:27], v[72:75], a[112:115], v[24:27]
    v_add_u32 v17, 0x1000, v17
    v_add_u32 v43, 932096, v43
    s_movk_i32 s87, 864
    v_lshrrev_b32 v46, 16, v43
    s_add_u32 m0, s88, 150528
    v_mad_u32_u24 v46, v46, s87, v17
    s_waitcnt vmcnt(5)
    buffer_load_dwordx4 v46, s[48:51], 0 offen nt lds
    s_waitcnt vmcnt(7)
    v_mfma_f32_16x16x32_bf16 v[24:27], v[76:79], a[116:119], v[24:27]
    v_add_u32 v17, 0x1000, v17
    v_add_u32 v43, 932096, v43
    s_movk_i32 s87, 864
    v_lshrrev_b32 v46, 16, v43
    s_add_u32 m0, s88, 154624
    v_mad_u32_u24 v46, v46, s87, v17
    s_waitcnt vmcnt(5)
    buffer_load_dwordx4 v46, s[48:51], 0 offen nt lds
    s_waitcnt vmcnt(7)
    v_mfma_f32_16x16x32_bf16 v[24:27], v[80:83], a[120:123], v[24:27]
    v_lshlrev_b32 v47, 4, v0
    v_mul_u32_u24 v48, 3641, v0
    s_movk_i32 s87, 864
    v_lshrrev_b32 v17, 16, v48
    v_mad_u32_u24 v17, v17, s87, v47
    v_add_u32 v47, 0x1000, v47
    v_add_u32 v48, 932096, v48
    s_movk_i32 s87, 864
    v_lshrrev_b32 v43, 16, v48
    v_mad_u32_u24 v43, v43, s87, v47
    v_add_u32 v47, 0x1000, v47
    v_add_u32 v48, 932096, v48
    s_movk_i32 s87, 864
    v_lshrrev_b32 v46, 16, v48
    v_mad_u32_u24 v46, v46, s87, v47
    v_add_u32 v47, 0x1000, v47
    v_add_u32 v48, 932096, v48
    s_movk_i32 s87, 864
    v_lshrrev_b32 v52, 16, v48
    v_mad_u32_u24 v52, v52, s87, v47
    v_add_u32 v47, 0x1000, v47
    v_add_u32 v48, 932096, v48
    s_movk_i32 s87, 864
    v_lshrrev_b32 v53, 16, v48
    v_mad_u32_u24 v53, v53, s87, v47
    s_waitcnt vmcnt(6)
    v_mfma_f32_16x16x32_bf16 v[24:27], v[84:87], a[124:127], v[24:27]
    s_nop 7
    v_pk_mul_f32 v[24:25], v[24:25], v[50:51] op_sel_hi:[1,0]
    v_pk_mul_f32 v[26:27], v[26:27], v[50:51] op_sel_hi:[1,0]
    ds_write_b128 v32, v[24:27]
    s_add_u32 m0, s88, 110592
    s_nop 0
    buffer_load_dwordx4 v17, s[52:55], 0 offen nt lds
    s_cmp_lg_u32 s22, 0
    s_waitcnt lgkmcnt(0)
    s_barrier
    s_mov_b64 exec, 0xffff
    ds_read_b128 v[56:59], v33 offset:0
    ds_read_b128 v[60:63], v33 offset:1024
    ds_read_b128 v[64:67], v33 offset:2048
    ds_read_b128 v[68:71], v33 offset:3072
    s_waitcnt lgkmcnt(2)
    v_pk_add_f32 v[56:57], v[56:57], v[60:61]
    v_pk_add_f32 v[58:59], v[58:59], v[62:63]
    s_waitcnt lgkmcnt(0)
    v_pk_add_f32 v[64:65], v[64:65], v[68:69]
    v_pk_add_f32 v[66:67], v[66:67], v[70:71]
    v_pk_add_f32 v[56:57], v[56:57], v[64:65]
    v_pk_add_f32 v[58:59], v[58:59], v[66:67]
    v_perm_b32 v56, v56, v12, s76
    v_perm_b32 v57, v57, v12, s77
    v_perm_b32 v58, v58, v12, s78
    v_perm_b32 v59, v59, v12, s79
    s_cbranch_scc1 L_alto
    buffer_store_dwordx4 v[56:59], v34, s[56:59], 0 offen
L_altbo:
    s_mov_b64 exec, -1
    s_add_u32 m0, s88, 114688
    s_nop 0
    buffer_load_dwordx4 v43, s[52:55], 0 offen nt lds
    s_add_u32 m0, s88, 118784
    s_nop 0
    buffer_load_dwordx4 v46, s[52:55], 0 offen nt lds
    s_add_u32 m0, s88, 122880
    s_nop 0
    buffer_load_dwordx4 v52, s[52:55], 0 offen nt lds
    s_add_u32 m0, s88, 126976
    s_nop 0
    buffer_load_dwordx4 v53, s[52:55], 0 offen nt lds
    ds_read_b64 v[72:73], v39 offset:0
    ds_read_b64 v[74:75], v39 offset:32
    ds_read_b64 v[76:77], v39 offset:64
    ds_read_b64 v[78:79], v39 offset:96
    ds_read_b64 v[80:81], v39 offset:128
    s_cmp_eq_u32 s3, 3
    s_waitcnt vmcnt(6) lgkmcnt(0)
    s_barrier
    buffer_load_dwordx4 v[28:31], v35, s[56:59], 0 offen sc1
    s_cbranch_scc1 L_noffn
    ds_read_b64_tr_b16 v[104:105], v40 offset:41984
    ds_read_b64_tr_b16 v[116:117], v40 offset:42016
    ds_read_b64_tr_b16 v[128:129], v40 offset:42048
    ds_read_b64_tr_b16 v[96:97], v40 offset:23552
    ds_read_b64_tr_b16 v[108:109], v40 offset:23584
    ds_read_b64_tr_b16 v[120:121], v40 offset:23616
    ds_read_b64_tr_b16 v[98:99], v40 offset:28160
    ds_read_b64_tr_b16 v[110:111], v40 offset:28192
    ds_read_b64_tr_b16 v[122:123], v40 offset:28224
    ds_read_b64_tr_b16 v[100:101], v40 offset:32768
    ds_read_b64_tr_b16 v[112:113], v40 offset:32800
    ds_read_b64_tr_b16 v[124:125], v40 offset:32832
    ds_read_b64_tr_b16 v[102:103], v40 offset:37376
    ds_read_b64_tr_b16 v[114:115], v40 offset:37408
    ds_read_b64_tr_b16 v[126:127], v40 offset:37440
    s_waitcnt lgkmcnt(12)
    v_mfma_f32_16x16x16_bf16 v[156:159], v[104:105], v[80:81], v[92:95]
    v_mfma_f32_16x16x16_bf16 v[160:163], v[116:117], v[80:81], v[92:95]
    v_mfma_f32_16x16x16_bf16 v[164:167], v[128:129], v[80:81], v[92:95]
    s_waitcnt lgkmcnt(6)
    s_nop 2
    v_mfma_f32_16x16x32_bf16 v[156:159], v[96:99], v[72:75], v[156:159]
    v_mfma_f32_16x16x32_bf16 v[160:163], v[108:111], v[72:75], v[160:163]
    v_mfma_f32_16x16x32_bf16 v[164:167], v[120:123], v[72:75], v[164:167]
    s_waitcnt lgkmcnt(0)
    v_mfma_f32_16x16x32_bf16 v[156:159], v[100:103], v[76:79], v[156:159]
    v_mfma_f32_16x16x32_bf16 v[160:163], v[112:115], v[76:79], v[160:163]
    v_mfma_f32_16x16x32_bf16 v[164:167], v[124:127], v[76:79], v[164:167]
L_noffn:
    s_mov_b64 vcc, -1
L_chk3:
    s_mov_b64 exec, vcc
    buffer_load_dwordx4 v[28:31], v35, s[56:59], 0 offen sc1
    s_mov_b64 exec, -1
    s_sub_u32 s86, s86, 1
    s_cbranch_scc1 L_end
    s_waitcnt vmcnt(1)
    v_perm_b32 v5, v29, v28, s80
    v_perm_b32 v6, v31, v30, s81
    v_or_b32 v5, v5, v6
    v_cmp_ne_u32 vcc, v5, v12
    s_cbranch_vccnz L_chk3
    v_and_b32 v84, 0xffffff00, v28
    v_and_b32 v85, 0xffffff00, v29
    v_and_b32 v86, 0xffffff00, v30
    v_and_b32 v87, 0xffffff00, v31
    v_pk_mul_f32 v[84:85], v[84:85], v[22:23] op_sel_hi:[1,0]
    v_pk_mul_f32 v[86:87], v[86:87], v[22:23] op_sel_hi:[1,0]
    s_nop 1
    v_permlane32_swap_b32 v84, v86
    v_permlane32_swap_b32 v85, v87
    v_add_f32 v84, v84, v86
    v_add_f32 v85, v85, v87
    s_nop 1
    v_permlane16_swap_b32 v84, v85
    v_add_f32 v84, v84, v85
    v_cvt_pk_bf16_f32 v84, v84, v84
    ds_write_b16 v37, v84
    s_add_u32 s72, s75, 63
    v_mov_b32 v7, s72
    v_mov_b32 v6, 0x40000000
    s_cmp_eq_u32 s3, 3
    s_waitcnt vmcnt(2) lgkmcnt(0)
    s_barrier
    s_cbranch_scc1 L_fin
    ds_read_b128 v[168:171], v38 offset:0
    ds_read_b64_tr_b16 v[132:133], v40 offset:0
    ds_read_b64_tr_b16 v[134:135], v40 offset:4608
    ds_read_b64_tr_b16 v[140:141], v40 offset:32
    ds_read_b64_tr_b16 v[142:143], v40 offset:4640
    ds_read_b64_tr_b16 v[148:149], v40 offset:64
    ds_read_b64_tr_b16 v[150:151], v40 offset:4672
    ds_read_b128 v[172:175], v38 offset:64
    ds_read_b64_tr_b16 v[136:137], v40 offset:9216
    ds_read_b64_tr_b16 v[138:139], v40 offset:13824
    ds_read_b64_tr_b16 v[144:145], v40 offset:9248
    ds_read_b64_tr_b16 v[146:147], v40 offset:13856
    ds_read_b64_tr_b16 v[152:153], v40 offset:9280
    ds_read_b64_tr_b16 v[154:155], v40 offset:13888
    s_waitcnt lgkmcnt(11)
    v_mfma_f32_16x16x32_bf16 v[156:159], v[132:135], v[168:171], v[156:159]
    s_waitcnt lgkmcnt(9)
    v_mfma_f32_16x16x32_bf16 v[160:163], v[140:143], v[168:171], v[160:163]
    s_waitcnt lgkmcnt(7)
    v_mfma_f32_16x16x32_bf16 v[164:167], v[148:151], v[168:171], v[164:167]
    s_waitcnt lgkmcnt(4)
    v_mfma_f32_16x16x32_bf16 v[156:159], v[136:139], v[172:175], v[156:159]
    s_waitcnt lgkmcnt(2)
    v_mfma_f32_16x16x32_bf16 v[160:163], v[144:147], v[172:175], v[160:163]
    s_waitcnt lgkmcnt(0)
    v_mfma_f32_16x16x32_bf16 v[164:167], v[152:155], v[172:175], v[164:167]
    s_nop 3
    v_cndmask_b32 v176, v156, 1.0, s[96:97]
    v_cndmask_b32 v177, v157, 1.0, s[96:97]
    v_cndmask_b32 v178, v158, 1.0, s[96:97]
    v_cndmask_b32 v179, v159, 1.0, s[96:97]
    v_cndmask_b32 v176, v176, v160, s[82:83]
    v_cndmask_b32 v177, v177, v161, s[82:83]
    v_cndmask_b32 v178, v178, v162, s[82:83]
    v_cndmask_b32 v179, v179, v163, s[82:83]
    v_cndmask_b32 v180, v176, v164, s[84:85]
    buffer_atomic_add_f32 v180, v41, s[56:59], 0 offen offset:0 sc0 sc1
    v_cndmask_b32 v181, v177, v165, s[84:85]
    buffer_atomic_add_f32 v181, v41, s[56:59], 0 offen offset:128 sc0 sc1
    v_cndmask_b32 v182, v178, v166, s[84:85]
    buffer_atomic_add_f32 v182, v41, s[56:59], 0 offen offset:256 sc0 sc1
    v_cndmask_b32 v183, v179, v167, s[84:85]
    buffer_atomic_add_f32 v183, v41, s[56:59], 0 offen offset:384 sc0 sc1
    v_cndmask_b32 v176, v176, v164, s[84:85]
    v_cndmask_b32 v177, v177, v165, s[84:85]
    v_cndmask_b32 v178, v178, v166, s[84:85]
    v_cndmask_b32 v179, v179, v167, s[84:85]
    s_waitcnt vmcnt(2)
L_chk4:
    v_sub_u32_dpp v184, v180, v7 quad_perm:[3,3,3,3] row_mask:0xf bank_mask:0xf
    v_sub_u32_dpp v185, v181, v7 quad_perm:[3,3,3,3] row_mask:0xf bank_mask:0xf
    v_pk_add_f32 v[168:169], v[180:181], v[176:177]
    v_or_b32 v5, v184, v185
    v_cvt_pk_bf16_f32 v172, v168, v169
    s_waitcnt vmcnt(0)
    v_sub_u32_dpp v186, v182, v7 quad_perm:[3,3,3,3] row_mask:0xf bank_mask:0xf
    v_sub_u32_dpp v187, v183, v7 quad_perm:[3,3,3,3] row_mask:0xf bank_mask:0xf
    v_or3_b32 v5, v5, v186, v187
    v_cmp_eq_u32 vcc, 0, v5
    v_pk_add_f32 v[170:171], v[182:183], v[178:179]
    v_cvt_pk_bf16_f32 v173, v170, v171
    v_cndmask_b32 v174, v6, v42, vcc
    buffer_store_dwordx2 v[172:173], v174, s[60:63], 0 offen
    v_min3_u32 v8, v184, v185, v186
    v_min_u32 v8, v8, v187
    s_movk_i32 s72, -63
    v_cmp_gt_u32 s[90:91], s72, v8
    v_cmp_eq_u32 s[94:95], 0, v184
    s_andn2_b64 s[90:91], s[90:91], vcc
    s_cbranch_scc0 L_mixedb
    v_cndmask_b32 v175, v6, v42, s[90:91]
    v_cmp_eq_u32 s[6:7], 0, v185
    v_cmp_eq_u32 s[8:9], 0, v186
    v_cmp_eq_u32 s[10:11], 0, v187
    v_cndmask_b32 v168, v6, v175, s[94:95]
    buffer_store_short v172, v168, s[60:63], 0 offen offset:0
    v_cndmask_b32 v169, v6, v175, s[6:7]
    buffer_store_short_d16_hi v172, v169, s[60:63], 0 offen offset:2
    v_cndmask_b32 v170, v6, v175, s[8:9]
    buffer_store_short v173, v170, s[60:63], 0 offen offset:4
    v_cndmask_b32 v171, v6, v175, s[10:11]
    buffer_store_short_d16_hi v173, v171, s[60:63], 0 offen offset:6
    v_add_u32 v184, 63, v184
    v_add_u32 v185, 63, v185
    v_add_u32 v186, 63, v186
    v_add_u32 v187, 63, v187
    v_max3_u32 v8, v184, v185, v186
    v_max_u32 v8, v8, v187
    v_cmp_lt_u32 vcc, 63, v8
    s_cbranch_vccnz L_mixed
L_mixedb:
    s_or_b32 s72, s65, s3
    s_cbranch_scc1 L_fin
    s_bitcmp1_b32 s94, 3
    s_cbranch_scc0 L_fin
    v_mov_b32 v5, s71
    v_mov_b32 v6, 0
    s_mov_b64 exec, 1
    buffer_store_dword v5, v6, s[56:59], 0 offen
L_fin:
    s_endpgm
L_slow1:
    s_sub_u32 s86, s86, 1
    s_cbranch_scc1 L_end
    s_mov_b64 s[90:91], 0
    v_perm_b32 v5, v49, v48, s80
    v_perm_b32 v6, v51, v50, s81
    v_or_b32 v5, v5, v6
    v_cmp_ne_u32 s[92:93], v5, v10
    v_xor_b32 v5, v5, v10
    v_lshlrev_b32 v5, 4, v5
    v_cmp_ne_u32 vcc, 0, v5
    s_nop 0
    s_or_b64 s[90:91], s[90:91], vcc
    s_andn2_b64 vcc, s[92:93], vcc
    s_cselect_b32 s22, 1, s22
    v_perm_b32 v5, v53, v52, s80
    v_perm_b32 v6, v55, v54, s81
    v_or_b32 v5, v5, v6
    v_cmp_ne_u32 s[92:93], v5, v10
    v_xor_b32 v5, v5, v10
    v_lshlrev_b32 v5, 4, v5
    v_cmp_ne_u32 vcc, 0, v5
    s_nop 0
    s_or_b64 s[90:91], s[90:91], vcc
    s_andn2_b64 vcc, s[92:93], vcc
    s_cselect_b32 s22, 1, s22
    s_mov_b32 exec_lo, 0x00030003
    s_mov_b32 exec_hi, 0x00030003
    v_perm_b32 v5, v57, v56, s80
    v_perm_b32 v6, v59, v58, s81
    v_or_b32 v5, v5, v6
    v_cmp_ne_u32 s[92:93], v5, v10
    v_xor_b32 v5, v5, v10
    v_lshlrev_b32 v5, 4, v5
    v_cmp_ne_u32 vcc, 0, v5
    s_nop 0
    s_or_b64 s[90:91], s[90:91], vcc
    s_andn2_b64 vcc, s[92:93], vcc
    s_cselect_b32 s22, 1, s22
    s_mov_b64 exec, -1
    s_cmp_eq_u64 s[90:91], 0
    s_cbranch_scc1 L_ok1
    s_add_u32 s23, s23, 1
    s_cmp_lt_u32 s23, 4
    s_cbranch_scc1 L_slow1b
    s_mul_i32 s72, s68, 2304
    s_add_u32 s72, s72, 4096
    v_lshl_add_u32 v43, v4, 4, s72
    buffer_load_dwordx4 v[60:63], v43, s[56:59], 0 offen offset:0 sc1
    s_waitcnt vmcnt(0)
    v_perm_b32 v5, v61, v60, s80
    v_perm_b32 v6, v63, v62, s81
    v_or_b32 v5, v5, v6
    v_cmp_ne_u32 vcc, v5, v10
    s_nop 0
    s_andn2_b64 exec, exec, vcc
    s_cbranch_execz L_cpa0
    buffer_store_dwordx4 v[60:63], v43, s[56:59], 0 offen offset:0 sc1
L_cpa0:
    s_mov_b64 exec, -1
    s_waitcnt vmcnt(0)
    buffer_load_dwordx4 v[60:63], v43, s[56:59], 0 offen offset:1024 sc1
    s_waitcnt vmcnt(0)
    v_perm_b32 v5, v61, v60, s80
    v_perm_b32 v6, v63, v62, s81
    v_or_b32 v5, v5, v6
    v_cmp_ne_u32 vcc, v5, v10
    s_nop 0
    s_andn2_b64 exec, exec, vcc
    s_cbranch_execz L_cpa1
    buffer_store_dwordx4 v[60:63], v43, s[56:59], 0 offen offset:1024 sc1
L_cpa1:
    s_mov_b64 exec, -1
    s_waitcnt vmcnt(0)
    s_mov_b64 exec, 0xff
    buffer_load_dwordx4 v[60:63], v43, s[56:59], 0 offen offset:2048 sc1
    s_waitcnt vmcnt(0)
    v_perm_b32 v5, v61, v60, s80
    v_perm_b32 v6, v63, v62, s81
    v_or_b32 v5, v5, v6
    v_cmp_ne_u32 vcc, v5, v10
    s_nop 0
    s_andn2_b64 exec, exec, vcc
    s_cbranch_execz L_cpa2
    buffer_store_dwordx4 v[60:63], v43, s[56:59], 0 offen offset:2048 sc1
L_cpa2:
    s_mov_b64 exec, -1
    s_waitcnt vmcnt(0)
L_slow1b:
    buffer_load_dwordx4 v[48:51], v11, s[56:59], 0 offen sc1
    buffer_load_dwordx4 v[52:55], v15, s[56:59], 0 offen sc1
    buffer_load_dwordx4 v[56:59], v16, s[56:59], 0 offen sc1
    s_waitcnt vmcnt(0)
    s_branch L_chk1
L_mode1:
    s_mul_i32 s72, s68, 2304
    s_add_u32 s72, s72, 4096
    v_lshl_add_u32 v43, v4, 4, s72
    buffer_load_dwordx4 v[60:63], v43, s[56:59], 0 offen offset:0 sc1
    s_waitcnt vmcnt(0)
    v_perm_b32 v5, v61, v60, s80
    v_perm_b32 v6, v63, v62, s81
    v_or_b32 v5, v5, v6
    v_cmp_ne_u32 vcc, v5, v10
    s_nop 0
    s_andn2_b64 exec, exec, vcc
    s_cbranch_execz L_cpb0
    buffer_store_dwordx4 v[60:63], v43, s[56:59], 0 offen offset:0 sc1
L_cpb0:
    s_mov_b64 exec, -1
    s_waitcnt vmcnt(0)
    buffer_load_dwordx4 v[60:63], v43, s[56:59], 0 offen offset:1024 sc1
    s_waitcnt vmcnt(0)
    v_perm_b32 v5, v61, v60, s80
    v_perm_b32 v6, v63, v62, s81
    v_or_b32 v5, v5, v6
    v_cmp_ne_u32 vcc, v5, v10
    s_nop 0
    s_andn2_b64 exec, exec, vcc
    s_cbranch_execz L_cpb1
    buffer_store_dwordx4 v[60:63], v43, s[56:59], 0 offen offset:1024 sc1
L_cpb1:
    s_mov_b64 exec, -1
    s_waitcnt vmcnt(0)
    s_mov_b64 exec, 0xff
    buffer_load_dwordx4 v[60:63], v43, s[56:59], 0 offen offset:2048 sc1
    s_waitcnt vmcnt(0)
    v_perm_b32 v5, v61, v60, s80
    v_perm_b32 v6, v63, v62, s81
    v_or_b32 v5, v5, v6
    v_cmp_ne_u32 vcc, v5, v10
    s_nop 0
    s_andn2_b64 exec, exec, vcc
    s_cbranch_execz L_cpb2
    buffer_store_dwordx4 v[60:63], v43, s[56:59], 0 offen offset:2048 sc1
L_cpb2:
    s_mov_b64 exec, -1
    s_waitcnt vmcnt(0)
    s_branch L_mode1b
L_altm:
    buffer_store_dwordx4 v[52:55], v5, s[56:59], 0 offen sc1
    s_nop 1
    s_branch L_altbm
L_slow2:
    s_sub_u32 s86, s86, 1
    s_cbranch_scc1 L_end
    buffer_load_dwordx4 v[88:91], v36, s[56:59], 0 offen sc1
    s_waitcnt vmcnt(0)
    s_branch L_chk2
L_alto:
    buffer_store_dwordx4 v[56:59], v34, s[56:59], 0 offen sc1
    s_nop 1
    s_branch L_altbo
L_mixed:
    s_sub_u32 s86, s86, 1
    s_cbranch_scc1 L_end
    v_cmp_lt_u32 vcc, 63, v184
    s_nop 0
    s_and_b64 exec, exec, vcc
    s_cbranch_scc0 L_rt0
    buffer_load_dword v18, v41, s[56:59], 0 offen offset:0 sc1
    s_waitcnt vmcnt(0)
    v_sub_u32_dpp v5, v18, v7 quad_perm:[3,3,3,3] row_mask:0xf bank_mask:0xf
    v_add_u32 v5, 63, v5
    v_cmp_ge_u32 vcc, 63, v5
    s_nop 0
    s_and_b64 exec, exec, vcc
    s_cbranch_scc0 L_rt0
    v_mov_b32 v180, v176
    buffer_atomic_add_f32 v180, v41, s[56:59], 0 offen offset:0 sc0 sc1
    s_waitcnt vmcnt(0)
L_rt0:
    s_mov_b64 exec, -1
    v_cmp_lt_u32 vcc, 63, v185
    s_nop 0
    s_and_b64 exec, exec, vcc
    s_cbranch_scc0 L_rt1
    buffer_load_dword v18, v41, s[56:59], 0 offen offset:128 sc1
    s_waitcnt vmcnt(0)
    v_sub_u32_dpp v5, v18, v7 quad_perm:[3,3,3,3] row_mask:0xf bank_mask:0xf
    v_add_u32 v5, 63, v5
    v_cmp_ge_u32 vcc, 63, v5
    s_nop 0
    s_and_b64 exec, exec, vcc
    s_cbranch_scc0 L_rt1
    v_mov_b32 v181, v177
    buffer_atomic_add_f32 v181, v41, s[56:59], 0 offen offset:128 sc0 sc1
    s_waitcnt vmcnt(0)
L_rt1:
    s_mov_b64 exec, -1
    v_cmp_lt_u32 vcc, 63, v186
    s_nop 0
    s_and_b64 exec, exec, vcc
    s_cbranch_scc0 L_rt2
    buffer_load_dword v18, v41, s[56:59], 0 offen offset:256 sc1
    s_waitcnt vmcnt(0)
    v_sub_u32_dpp v5, v18, v7 quad_perm:[3,3,3,3] row_mask:0xf bank_mask:0xf
    v_add_u32 v5, 63, v5
    v_cmp_ge_u32 vcc, 63, v5
    s_nop 0
    s_and_b64 exec, exec, vcc
    s_cbranch_scc0 L_rt2
    v_mov_b32 v182, v178
    buffer_atomic_add_f32 v182, v41, s[56:59], 0 offen offset:256 sc0 sc1
    s_waitcnt vmcnt(0)
L_rt2:
    s_mov_b64 exec, -1
    v_cmp_lt_u32 vcc, 63, v187
    s_nop 0
    s_and_b64 exec, exec, vcc
    s_cbranch_scc0 L_rt3
    buffer_load_dword v18, v41, s[56:59], 0 offen offset:384 sc1
    s_waitcnt vmcnt(0)
    v_sub_u32_dpp v5, v18, v7 quad_perm:[3,3,3,3] row_mask:0xf bank_mask:0xf
    v_add_u32 v5, 63, v5
    v_cmp_ge_u32 vcc, 63, v5
    s_nop 0
    s_and_b64 exec, exec, vcc
    s_cbranch_scc0 L_rt3
    v_mov_b32 v183, v179
    buffer_atomic_add_f32 v183, v41, s[56:59], 0 offen offset:384 sc0 sc1
    s_waitcnt vmcnt(0)
L_rt3:
    s_mov_b64 exec, -1
    s_branch L_chk4
L_end:
    s_endpgm
.section .rodata,"a"
.p2align 6
.amdhsa_kernel parallel_sum__sliding_block_cached__dense_activation_silu__decode_kernel
  .amdhsa_next_free_vgpr 316
  .amdhsa_next_free_sgpr 102
  .amdhsa_accum_offset 188
  .amdhsa_group_segment_fixed_size 0
  .amdhsa_kernarg_size 88
  .amdhsa_user_sgpr_count 2
  .amdhsa_user_sgpr_kernarg_segment_ptr 1
  .amdhsa_system_sgpr_workgroup_id_x 1
.end_amdhsa_kernel
```
